```python
import torch

def _softmax(x, axis=-1):
    return torch.softmax(x, dim=axis)
def _gelu(x):
    return torch.nn.functional.gelu(x, approximate="tanh")
def _silu(x):
    return torch.nn.functional.silu(x)
def _sigmoid(x):
    return torch.sigmoid(x)
def _layernorm(x, axis=-1, eps=1e-5):
    m = x.mean(dim=axis, keepdim=True)
    v = x.var(dim=axis, keepdim=True, unbiased=False)
    return (x - m) / torch.sqrt(v + eps)
def _scatter_add(tgt, idx, src, axis=0):
    return tgt.clone().index_add_(axis, idx, src)
def _segment_sum(src, seg, n):
    out = torch.zeros((n,) + src.shape[1:], dtype=src.dtype)
    return out.index_add_(0, seg, src)
def _pad(x, pw):
    flat = tuple(v for pair in reversed(pw) for v in pair)
    return torch.nn.functional.pad(x, flat)

kernel_name = 'interleave_layers__sliding_block_cached__glu_gated_swiglu__decode'

def setup_inputs():

    _w = (lambda a: (lambda t: t.to(torch.bfloat16) if t.is_floating_point() else t)(torch.as_tensor(a)))
    def _A_setup():
        B, Sq, D = 1, 1, 512
        Hq, Hkv, Sk, Dh = 32, 8, 32768, 128
        assert Hq % Hkv == 0, (Hq, Hkv)
        return {
            "x": _w((lambda *s: torch.randn(*s, dtype=torch.bfloat16) * 0.05)(B, Sq, D)),
            "k_cache": _w((lambda *s: torch.randn(*s, dtype=torch.bfloat16) * 0.8)(B, Hkv, Sk, Dh)),
            "v_cache": _w((lambda *s: torch.randn(*s, dtype=torch.bfloat16) * 0.8)(B, Hkv, Sk, Dh)),
            "wq": _w((lambda *s: torch.randn(*s, dtype=torch.bfloat16) * 0.8)(D, Hq * Dh) * (D ** -0.5)),
            "wo": _w((lambda *s: torch.randn(*s, dtype=torch.bfloat16) * 0.8)(Hq * Dh, D) * ((Hq * Dh) ** -0.5)),
        }
    _A_in = _A_setup()

    def _B_setup():
        B, S, D, F = 1, 1, 512, 1792
        return {
            "x": _w((lambda *s: torch.randn(*s, dtype=torch.bfloat16) * 0.05)(B, S, D)),
            "w1": _w((lambda *s: torch.randn(*s, dtype=torch.bfloat16) * 0.2)(D, F) * (2.0 / D) ** 0.5),
            "w3": _w((lambda *s: torch.randn(*s, dtype=torch.bfloat16) * 0.2)(D, F) * (2.0 / D) ** 0.5),
            "w2": _w((lambda *s: torch.randn(*s, dtype=torch.bfloat16) * 0.2)(F, D) * (2.0 / F) ** 0.5),
        }
    _B_in = _B_setup()

    return {
        "A_x": _A_in["x"],
        "A_k_cache": _A_in["k_cache"],
        "A_v_cache": _A_in["v_cache"],
        "A_wq": _A_in["wq"],
        "A_wo": _A_in["wo"],
        "B_x": _B_in["x"],
        "B_w1": _B_in["w1"],
        "B_w3": _B_in["w3"],
        "B_w2": _B_in["w2"],
    }

def reference(A_x, A_k_cache, A_v_cache, A_wq, A_wo, B_x, B_w1, B_w3, B_w2):
    def _A_ref(x, k_cache, v_cache, wq, wo):
        B, Sq, D = x.shape
        Hq, Dh = 32, 128
        Hkv, Sk = k_cache.shape[1], k_cache.shape[2]
        W = min(4096, max(256, Sk // 4))
        rep = Hq // Hkv
        q = (lambda x, *d: x.permute(*d))((x @ wq).reshape(B, Sq, Hq, Dh), 0, 2, 1, 3)
        k = (lambda x, n, axis: torch.repeat_interleave(x, n, dim=axis))(k_cache[:, :, Sk - W:, :], rep, axis=1)
        v = (lambda x, n, axis: torch.repeat_interleave(x, n, dim=axis))(v_cache[:, :, Sk - W:, :], rep, axis=1)
        scores = torch.einsum("bhqd,bhkd->bhqk", q, k) * (Dh ** -0.5)
        p = _softmax(scores, axis=-1)
        o = torch.einsum("bhqk,bhkd->bhqd", p, v)
        return (lambda x, *d: x.permute(*d))(o, 0, 2, 1, 3).reshape(B, Sq, Hq * Dh) @ wo

    def _B_ref(x, w1, w3, w2):
        gate = torch.einsum("bsd,df->bsf", x, w1)
        up = torch.einsum("bsd,df->bsf", x, w3)
        h = _silu(gate) * up
        out = torch.einsum("bsf,fd->bsd", h, w2)
        return out

    x = A_x
    x = x + _A_ref(_layernorm(x, axis=-1), A_k_cache, A_v_cache, A_wq, A_wo)
    x = x + _B_ref(_layernorm(x, axis=-1), B_w1, B_w3, B_w2)
    x = x + _A_ref(_layernorm(x, axis=-1), A_k_cache, A_v_cache, A_wq, A_wo)
    x = x + _B_ref(_layernorm(x, axis=-1), B_w1, B_w3, B_w2)
    return x
```

```asm
; @launch grid=(256,1,1) block=(576,1,1) lds=126976
.amdgcn_target "amdgcn-amd-amdhsa--gfx950"
.text
.globl interleave_layers__sliding_block_cached__glu_gated_swiglu__decode_kernel
.p2align 8
.type interleave_layers__sliding_block_cached__glu_gated_swiglu__decode_kernel,@function
interleave_layers__sliding_block_cached__glu_gated_swiglu__decode_kernel:
    s_cmp_ge_u32 s2, 256
    s_cbranch_scc1 L_end
    s_load_dwordx16 s[4:19], s[0:1], 0
    s_load_dwordx8 s[20:27], s[0:1], 64
    v_lshrrev_b32 v2, 6, v0
    v_and_b32 v1, 63, v0
    s_and_b32 s28, s2, 7
    s_lshr_b32 s29, s2, 3
    v_readfirstlane_b32 s30, v2
    s_mov_b32 s35, 0
    s_and_b32 s31, s30, 3
    s_cmp_eq_u32 s30, 8
    s_cbranch_scc0 L_AD
    v_mov_b32 v13, 0
    v_lshlrev_b32 v14, 2, v1
    ds_write_b32 v14, v13 offset:2624
    v_mov_b32 v12, 1
    v_lshrrev_b32 v14, 1, v1
    v_and_b32 v15, 1, v1
    v_lshlrev_b32 v15, 4, v15
    s_lshl_b32 s45, s28, 10
    s_lshl_b32 s46, s29, 5
    s_add_u32 s45, s45, s46
    v_lshl_add_u32 v2, v14, 13, v15
    v_add_u32 v2, s45, v2
    v_lshl_add_u32 v11, v14, 10, v15
    v_add_u32 v11, s46, v11
    v_lshrrev_b32 v14, 3, v1
    v_and_b32 v15, 7, v1
    v_lshlrev_b32 v15, 7, v15
    v_lshl_add_u32 v16, v14, 13, v15
    s_lshl_b32 s45, s29, 17
    s_lshl_b32 s46, s28, 10
    s_add_u32 s45, s45, s46
    v_add_u32 v16, s45, v16
    s_waitcnt lgkmcnt(0)
    s_barrier
    s_mov_b32 s36, s10
    s_and_b32 s37, s11, 0xffff
    s_mov_b32 s38, 4194304
    s_mov_b32 s39, 0x20000
    s_mov_b32 s48, 0
    buffer_load_dword v20, v16, s[36:39], s48 offen nt
    s_mov_b32 s48, 65536
    buffer_load_dword v20, v16, s[36:39], s48 offen nt
    s_mov_b32 s48, 0
    s_mov_b32 m0, 4096
    s_nop 0
    buffer_load_dwordx4 v2, s[36:39], s48 offen nt lds
    s_mov_b32 s48, 262144
    s_mov_b32 m0, 5120
    s_nop 0
    buffer_load_dwordx4 v2, s[36:39], s48 offen nt lds
    s_mov_b32 s48, 524288
    s_mov_b32 m0, 6144
    s_nop 0
    buffer_load_dwordx4 v2, s[36:39], s48 offen nt lds
    s_mov_b32 s48, 786432
    s_mov_b32 m0, 7168
    s_nop 0
    buffer_load_dwordx4 v2, s[36:39], s48 offen nt lds
    s_mov_b32 s48, 1048576
    s_mov_b32 m0, 8192
    s_nop 0
    buffer_load_dwordx4 v2, s[36:39], s48 offen nt lds
    s_mov_b32 s48, 1310720
    s_mov_b32 m0, 9216
    s_nop 0
    buffer_load_dwordx4 v2, s[36:39], s48 offen nt lds
    s_mov_b32 s48, 1572864
    s_mov_b32 m0, 10240
    s_nop 0
    buffer_load_dwordx4 v2, s[36:39], s48 offen nt lds
    s_mov_b32 s48, 1835008
    s_mov_b32 m0, 11264
    s_nop 0
    buffer_load_dwordx4 v2, s[36:39], s48 offen nt lds
    s_mov_b32 s48, 2097152
    s_mov_b32 m0, 12288
    s_nop 0
    buffer_load_dwordx4 v2, s[36:39], s48 offen nt lds
    s_mov_b32 s48, 2359296
    s_mov_b32 m0, 13312
    s_nop 0
    buffer_load_dwordx4 v2, s[36:39], s48 offen nt lds
    s_mov_b32 s48, 2621440
    s_mov_b32 m0, 14336
    s_nop 0
    buffer_load_dwordx4 v2, s[36:39], s48 offen nt lds
    s_mov_b32 s48, 2883584
    s_mov_b32 m0, 15360
    s_nop 0
    buffer_load_dwordx4 v2, s[36:39], s48 offen nt lds
    s_mov_b32 s48, 3145728
    s_mov_b32 m0, 16384
    s_nop 0
    buffer_load_dwordx4 v2, s[36:39], s48 offen nt lds
    s_mov_b32 s48, 3407872
    s_mov_b32 m0, 17408
    s_nop 0
    buffer_load_dwordx4 v2, s[36:39], s48 offen nt lds
    s_mov_b32 s48, 3670016
    s_mov_b32 m0, 18432
    s_nop 0
    buffer_load_dwordx4 v2, s[36:39], s48 offen nt lds
    s_mov_b32 s48, 3932160
    s_mov_b32 m0, 19456
    s_nop 0
    buffer_load_dwordx4 v2, s[36:39], s48 offen nt lds
    v_lshrrev_b32 v14, 4, v1
    v_and_b32 v15, 15, v1
    v_xor_b32 v3, v15, v14
    v_lshlrev_b32 v3, 4, v3
    v_lshl_add_u32 v3, v14, 8, v3
    v_xor_b32 v4, 64, v3
    v_xor_b32 v5, 128, v3
    v_xor_b32 v6, 192, v3
    v_lshlrev_b32 v7, 1, v14
    v_xor_b32 v15, v15, v7
    v_lshlrev_b32 v15, 4, v15
    v_lshl_add_u32 v7, v14, 8, v15
    v_xor_b32 v8, 128, v7
    s_mov_b32 s40, s6
    s_and_b32 s41, s7, 0xffff
    s_mov_b32 s42, 67108864
    s_mov_b32 s43, 0x20000
    s_mov_b32 s52, s8
    s_and_b32 s53, s9, 0xffff
    s_mov_b32 s54, 67108864
    s_mov_b32 s55, 0x20000
    s_lshl_b32 s45, s28, 23
    s_lshl_b32 s46, s29, 15
    s_add_u32 s45, s45, s46
    s_add_u32 s45, s45, 7340032
    s_add_u32 s48, s45, 0
    s_mov_b32 m0, 94208
    s_nop 0
    buffer_load_dwordx4 v3, s[40:43], s48 offen nt lds
    s_add_u32 s48, s45, 1024
    s_mov_b32 m0, 95232
    s_nop 0
    buffer_load_dwordx4 v4, s[40:43], s48 offen nt lds
    s_add_u32 s48, s45, 2048
    s_mov_b32 m0, 96256
    s_nop 0
    buffer_load_dwordx4 v5, s[40:43], s48 offen nt lds
    s_add_u32 s48, s45, 3072
    s_mov_b32 m0, 97280
    s_nop 0
    buffer_load_dwordx4 v6, s[40:43], s48 offen nt lds
    s_add_u32 s48, s45, 4096
    s_mov_b32 m0, 98304
    s_nop 0
    buffer_load_dwordx4 v3, s[40:43], s48 offen nt lds
    s_add_u32 s48, s45, 5120
    s_mov_b32 m0, 99328
    s_nop 0
    buffer_load_dwordx4 v4, s[40:43], s48 offen nt lds
    s_add_u32 s48, s45, 6144
    s_mov_b32 m0, 100352
    s_nop 0
    buffer_load_dwordx4 v5, s[40:43], s48 offen nt lds
    s_add_u32 s48, s45, 7168
    s_mov_b32 m0, 101376
    s_nop 0
    buffer_load_dwordx4 v6, s[40:43], s48 offen nt lds
    s_add_u32 s48, s45, 8192
    s_mov_b32 m0, 102400
    s_nop 0
    buffer_load_dwordx4 v3, s[40:43], s48 offen nt lds
    s_add_u32 s48, s45, 9216
    s_mov_b32 m0, 103424
    s_nop 0
    buffer_load_dwordx4 v4, s[40:43], s48 offen nt lds
    s_add_u32 s48, s45, 10240
    s_mov_b32 m0, 104448
    s_nop 0
    buffer_load_dwordx4 v5, s[40:43], s48 offen nt lds
    s_add_u32 s48, s45, 11264
    s_mov_b32 m0, 105472
    s_nop 0
    buffer_load_dwordx4 v6, s[40:43], s48 offen nt lds
    s_add_u32 s48, s45, 12288
    s_mov_b32 m0, 106496
    s_nop 0
    buffer_load_dwordx4 v3, s[40:43], s48 offen nt lds
    s_add_u32 s48, s45, 13312
    s_mov_b32 m0, 107520
    s_nop 0
    buffer_load_dwordx4 v4, s[40:43], s48 offen nt lds
    s_add_u32 s48, s45, 14336
    s_mov_b32 m0, 108544
    s_nop 0
    buffer_load_dwordx4 v5, s[40:43], s48 offen nt lds
    s_add_u32 s48, s45, 15360
    s_mov_b32 m0, 109568
    s_nop 0
    buffer_load_dwordx4 v6, s[40:43], s48 offen nt lds
    v_lshrrev_b32 v14, 1, v1
    v_and_b32 v14, 3, v14
    v_lshlrev_b32 v14, 7, v14
    v_lshrrev_b32 v15, 5, v1
    v_lshl_add_u32 v14, v15, 2, v14
    v_lshrrev_b32 v15, 3, v1
    v_and_b32 v15, 3, v15
    v_add_u32 v14, v14, v15
    v_lshlrev_b32 v14, 10, v14
    v_and_b32 v15, 1, v1
    v_lshlrev_b32 v15, 4, v15
    s_lshl_b32 s46, s29, 5
    v_add3_u32 v9, v14, v15, s46
    v_lshrrev_b32 v14, 1, v1
    s_movk_i32 s46, 3584
    v_mul_lo_u32 v10, v14, s46
    v_and_b32 v15, 1, v1
    v_lshl_add_u32 v10, v15, 4, v10
    s_mul_i32 s46, s28, 448
    s_lshr_b32 s47, s29, 1
    s_lshl_b32 s47, s47, 5
    s_add_u32 s46, s46, s47
    s_cmp_ge_u32 s29, 28
    s_cselect_b32 s46, 0x7f000000, s46
    v_add_u32 v10, s46, v10
    s_lshl_b32 s46, s29, 14
    v_lshlrev_b32 v17, 7, v1
    v_add_u32 v17, s46, v17
    v_lshrrev_b32 v14, 2, v1
    s_lshl_b32 s46, s29, 4
    v_add_u32 v14, s46, v14
    s_movk_i32 s46, 3584
    v_mul_lo_u32 v14, v14, s46
    v_and_b32 v15, 3, v1
    v_lshlrev_b32 v15, 7, v15
    s_mul_i32 s46, s28, 448
    s_and_b32 s46, s46, 0xffffff80
    v_add3_u32 v18, v14, v15, s46
    s_mul_i32 s46, s29, 7168
    v_lshlrev_b32 v19, 7, v1
    v_add_u32 v19, s46, v19
    v_cmp_gt_u32 vcc, 56, v1
    v_mov_b32 v14, 0x7f000000
    s_nop 0
    v_cndmask_b32 v19, v14, v19, vcc
    s_lshl_b32 s46, s29, 14
    s_add_u32 s46, s46, 384
    v_lshlrev_b32 v17, 10, v1
    v_add_u32 v17, s46, v17
    v_cmp_gt_u32 vcc, 16, v1
    v_mov_b32 v14, 0x7f000000
    s_nop 0
    v_cndmask_b32 v17, v14, v17, vcc
    s_mov_b32 s56, s12
    s_and_b32 s57, s13, 0xffff
    s_mov_b32 s58, 4194304
    s_mov_b32 s59, 0x20000
    s_mov_b32 s60, s16
    s_and_b32 s61, s17, 0xffff
    s_mov_b32 s62, 1835008
    s_mov_b32 s63, 0x20000
    s_bitcmp1_b32 s29, 0
    s_cselect_b32 s12, s18, s16
    s_cselect_b32 s13, s19, s17
    s_and_b32 s13, s13, 0xffff
    s_mov_b32 s14, 1835008
    s_mov_b32 s15, 0x20000
    s_mov_b32 s4, s18
    s_and_b32 s5, s19, 0xffff
    s_mov_b32 s6, 1835008
    s_mov_b32 s7, 0x20000
    s_mov_b32 s8, s20
    s_and_b32 s9, s21, 0xffff
    s_mov_b32 s10, 1835008
    s_mov_b32 s11, 0x20000
    s_lshl_b32 s46, s28, 19
    s_mul_i32 s47, s28, 229376
    s_waitcnt vmcnt(23)
    s_add_u32 s48, s45, 16384
    s_mov_b32 m0, 110592
    s_nop 0
    buffer_load_dwordx4 v3, s[40:43], s48 offen nt lds
    s_waitcnt vmcnt(23)
    s_add_u32 s48, s45, 17408
    s_mov_b32 m0, 111616
    s_nop 0
    buffer_load_dwordx4 v4, s[40:43], s48 offen nt lds
    s_waitcnt vmcnt(23)
    s_add_u32 s48, s45, 18432
    s_mov_b32 m0, 112640
    s_nop 0
    buffer_load_dwordx4 v5, s[40:43], s48 offen nt lds
    s_waitcnt vmcnt(23)
    s_add_u32 s48, s45, 19456
    s_mov_b32 m0, 113664
    s_nop 0
    buffer_load_dwordx4 v6, s[40:43], s48 offen nt lds
    s_waitcnt vmcnt(23)
    s_add_u32 s48, s45, 20480
    s_mov_b32 m0, 114688
    s_nop 0
    buffer_load_dwordx4 v3, s[40:43], s48 offen nt lds
    s_waitcnt vmcnt(23)
    s_add_u32 s48, s45, 21504
    s_mov_b32 m0, 115712
    s_nop 0
    buffer_load_dwordx4 v4, s[40:43], s48 offen nt lds
    s_waitcnt vmcnt(23)
    s_add_u32 s48, s45, 22528
    s_mov_b32 m0, 116736
    s_nop 0
    buffer_load_dwordx4 v5, s[40:43], s48 offen nt lds
    s_waitcnt vmcnt(23)
    s_mov_b64 exec, 1
    ds_write_b32 v13, v12 offset:2624
    s_mov_b64 exec, -1
    s_add_u32 s48, s45, 23552
    s_mov_b32 m0, 117760
    s_nop 0
    buffer_load_dwordx4 v6, s[40:43], s48 offen nt lds
    s_waitcnt vmcnt(23)
    s_add_u32 s48, s45, 24576
    s_mov_b32 m0, 118784
    s_nop 0
    buffer_load_dwordx4 v3, s[40:43], s48 offen nt lds
    s_waitcnt vmcnt(23)
    s_add_u32 s48, s45, 25600
    s_mov_b32 m0, 119808
    s_nop 0
    buffer_load_dwordx4 v4, s[40:43], s48 offen nt lds
    s_waitcnt vmcnt(23)
    s_add_u32 s48, s45, 26624
    s_mov_b32 m0, 120832
    s_nop 0
    buffer_load_dwordx4 v5, s[40:43], s48 offen nt lds
    s_waitcnt vmcnt(23)
    s_add_u32 s48, s45, 27648
    s_mov_b32 m0, 121856
    s_nop 0
    buffer_load_dwordx4 v6, s[40:43], s48 offen nt lds
    s_waitcnt vmcnt(23)
    s_add_u32 s48, s45, 28672
    s_mov_b32 m0, 122880
    s_nop 0
    buffer_load_dwordx4 v3, s[40:43], s48 offen nt lds
    s_waitcnt vmcnt(23)
    s_add_u32 s48, s45, 29696
    s_mov_b32 m0, 123904
    s_nop 0
    buffer_load_dwordx4 v4, s[40:43], s48 offen nt lds
    s_waitcnt vmcnt(23)
    s_add_u32 s48, s45, 30720
    s_mov_b32 m0, 124928
    s_nop 0
    buffer_load_dwordx4 v5, s[40:43], s48 offen nt lds
    s_waitcnt vmcnt(23)
    s_add_u32 s48, s45, 31744
    s_mov_b32 m0, 125952
    s_nop 0
    buffer_load_dwordx4 v6, s[40:43], s48 offen nt lds
    s_waitcnt vmcnt(23)
    s_add_u32 s48, s45, 0
    s_mov_b32 m0, 61440
    s_nop 0
    buffer_load_dwordx4 v7, s[52:55], s48 offen nt lds
    s_waitcnt vmcnt(23)
    s_add_u32 s48, s45, 1024
    s_mov_b32 m0, 62464
    s_nop 0
    buffer_load_dwordx4 v8, s[52:55], s48 offen nt lds
    s_waitcnt vmcnt(23)
    s_add_u32 s48, s45, 2048
    s_mov_b32 m0, 63488
    s_nop 0
    buffer_load_dwordx4 v7, s[52:55], s48 offen nt lds
    s_waitcnt vmcnt(23)
    s_add_u32 s48, s45, 3072
    s_mov_b32 m0, 64512
    s_nop 0
    buffer_load_dwordx4 v8, s[52:55], s48 offen nt lds
    s_waitcnt vmcnt(23)
    s_add_u32 s48, s45, 4096
    s_mov_b32 m0, 65536
    s_nop 0
    buffer_load_dwordx4 v7, s[52:55], s48 offen nt lds
    s_waitcnt vmcnt(23)
    s_add_u32 s48, s45, 5120
    s_mov_b32 m0, 66560
    s_nop 0
    buffer_load_dwordx4 v8, s[52:55], s48 offen nt lds
    s_waitcnt vmcnt(23)
    s_add_u32 s48, s45, 6144
    s_mov_b32 m0, 67584
    s_nop 0
    buffer_load_dwordx4 v7, s[52:55], s48 offen nt lds
    s_waitcnt vmcnt(23)
    s_add_u32 s48, s45, 7168
    s_mov_b32 m0, 68608
    s_nop 0
    buffer_load_dwordx4 v8, s[52:55], s48 offen nt lds
    s_waitcnt vmcnt(23)
    s_add_u32 s48, s45, 8192
    s_mov_b32 m0, 69632
    s_nop 0
    buffer_load_dwordx4 v7, s[52:55], s48 offen nt lds
    s_waitcnt vmcnt(23)
    s_add_u32 s48, s45, 9216
    s_mov_b32 m0, 70656
    s_nop 0
    buffer_load_dwordx4 v8, s[52:55], s48 offen nt lds
    s_waitcnt vmcnt(23)
    s_add_u32 s48, s45, 10240
    s_mov_b32 m0, 71680
    s_nop 0
    buffer_load_dwordx4 v7, s[52:55], s48 offen nt lds
    s_waitcnt vmcnt(23)
    s_add_u32 s48, s45, 11264
    s_mov_b32 m0, 72704
    s_nop 0
    buffer_load_dwordx4 v8, s[52:55], s48 offen nt lds
    s_waitcnt vmcnt(23)
    s_add_u32 s48, s45, 12288
    s_mov_b32 m0, 73728
    s_nop 0
    buffer_load_dwordx4 v7, s[52:55], s48 offen nt lds
    s_waitcnt vmcnt(23)
    s_add_u32 s48, s45, 13312
    s_mov_b32 m0, 74752
    s_nop 0
    buffer_load_dwordx4 v8, s[52:55], s48 offen nt lds
    s_waitcnt vmcnt(23)
    s_add_u32 s48, s45, 14336
    s_mov_b32 m0, 75776
    s_nop 0
    buffer_load_dwordx4 v7, s[52:55], s48 offen nt lds
    s_waitcnt vmcnt(23)
    s_add_u32 s48, s45, 15360
    s_mov_b32 m0, 76800
    s_nop 0
    buffer_load_dwordx4 v8, s[52:55], s48 offen nt lds
    s_waitcnt vmcnt(23)
    s_add_u32 s48, s45, 16384
    s_mov_b32 m0, 77824
    s_nop 0
    buffer_load_dwordx4 v7, s[52:55], s48 offen nt lds
    s_waitcnt vmcnt(23)
    s_add_u32 s48, s45, 17408
    s_mov_b32 m0, 78848
    s_nop 0
    buffer_load_dwordx4 v8, s[52:55], s48 offen nt lds
    s_waitcnt vmcnt(23)
    s_add_u32 s48, s45, 18432
    s_mov_b32 m0, 79872
    s_nop 0
    buffer_load_dwordx4 v7, s[52:55], s48 offen nt lds
    s_waitcnt vmcnt(23)
    s_add_u32 s48, s45, 19456
    s_mov_b32 m0, 80896
    s_nop 0
    buffer_load_dwordx4 v8, s[52:55], s48 offen nt lds
    s_waitcnt vmcnt(23)
    s_add_u32 s48, s45, 20480
    s_mov_b32 m0, 81920
    s_nop 0
    buffer_load_dwordx4 v7, s[52:55], s48 offen nt lds
    s_waitcnt vmcnt(23)
    s_add_u32 s48, s45, 21504
    s_mov_b32 m0, 82944
    s_nop 0
    buffer_load_dwordx4 v8, s[52:55], s48 offen nt lds
    s_waitcnt vmcnt(23)
    s_add_u32 s48, s45, 22528
    s_mov_b32 m0, 83968
    s_nop 0
    buffer_load_dwordx4 v7, s[52:55], s48 offen nt lds
    s_waitcnt vmcnt(23)
    s_mov_b64 exec, 1
    ds_write_b32 v13, v12 offset:2628
    s_mov_b64 exec, -1
    s_add_u32 s48, s45, 23552
    s_mov_b32 m0, 84992
    s_nop 0
    buffer_load_dwordx4 v8, s[52:55], s48 offen nt lds
    s_waitcnt vmcnt(23)
    s_add_u32 s48, s45, 24576
    s_mov_b32 m0, 86016
    s_nop 0
    buffer_load_dwordx4 v7, s[52:55], s48 offen nt lds
    s_waitcnt vmcnt(23)
    s_add_u32 s48, s45, 25600
    s_mov_b32 m0, 87040
    s_nop 0
    buffer_load_dwordx4 v8, s[52:55], s48 offen nt lds
    s_waitcnt vmcnt(23)
    s_add_u32 s48, s45, 26624
    s_mov_b32 m0, 88064
    s_nop 0
    buffer_load_dwordx4 v7, s[52:55], s48 offen nt lds
    s_waitcnt vmcnt(23)
    s_add_u32 s48, s45, 27648
    s_mov_b32 m0, 89088
    s_nop 0
    buffer_load_dwordx4 v8, s[52:55], s48 offen nt lds
    s_waitcnt vmcnt(23)
    s_add_u32 s48, s45, 28672
    s_mov_b32 m0, 90112
    s_nop 0
    buffer_load_dwordx4 v7, s[52:55], s48 offen nt lds
    s_waitcnt vmcnt(23)
    s_add_u32 s48, s45, 29696
    s_mov_b32 m0, 91136
    s_nop 0
    buffer_load_dwordx4 v8, s[52:55], s48 offen nt lds
    s_waitcnt vmcnt(23)
    s_add_u32 s48, s45, 30720
    s_mov_b32 m0, 92160
    s_nop 0
    buffer_load_dwordx4 v7, s[52:55], s48 offen nt lds
    s_waitcnt vmcnt(23)
    s_add_u32 s48, s45, 31744
    s_mov_b32 m0, 93184
    s_nop 0
    buffer_load_dwordx4 v8, s[52:55], s48 offen nt lds
    s_waitcnt vmcnt(23)
    s_add_u32 s48, s46, 0
    buffer_load_dword v20, v17, s[56:59], s48 offen
    s_waitcnt vmcnt(7)
    s_add_u32 s48, s46, 0
    s_mov_b32 m0, 20480
    s_nop 0
    buffer_load_dwordx4 v9, s[56:59], s48 offen nt lds
    s_waitcnt vmcnt(7)
    s_add_u32 s48, s46, 8192
    s_mov_b32 m0, 21504
    s_nop 0
    buffer_load_dwordx4 v9, s[56:59], s48 offen nt lds
    s_waitcnt vmcnt(7)
    s_add_u32 s48, s46, 16384
    s_mov_b32 m0, 22528
    s_nop 0
    buffer_load_dwordx4 v9, s[56:59], s48 offen nt lds
    s_waitcnt vmcnt(7)
    s_add_u32 s48, s46, 24576
    s_mov_b32 m0, 23552
    s_nop 0
    buffer_load_dwordx4 v9, s[56:59], s48 offen nt lds
    s_waitcnt vmcnt(7)
    s_add_u32 s48, s46, 32768
    s_mov_b32 m0, 24576
    s_nop 0
    buffer_load_dwordx4 v9, s[56:59], s48 offen nt lds
    s_waitcnt vmcnt(7)
    s_add_u32 s48, s46, 40960
    s_mov_b32 m0, 25600
    s_nop 0
    buffer_load_dwordx4 v9, s[56:59], s48 offen nt lds
    s_waitcnt vmcnt(7)
    s_mov_b64 exec, 1
    ds_write_b32 v13, v12 offset:2632
    s_mov_b64 exec, -1
    s_add_u32 s48, s46, 49152
    s_mov_b32 m0, 26624
    s_nop 0
    buffer_load_dwordx4 v9, s[56:59], s48 offen nt lds
    s_waitcnt vmcnt(7)
    s_add_u32 s48, s46, 57344
    s_mov_b32 m0, 27648
    s_nop 0
    buffer_load_dwordx4 v9, s[56:59], s48 offen nt lds
    s_waitcnt vmcnt(7)
    s_add_u32 s48, s46, 65536
    s_mov_b32 m0, 28672
    s_nop 0
    buffer_load_dwordx4 v9, s[56:59], s48 offen nt lds
    s_waitcnt vmcnt(7)
    s_add_u32 s48, s46, 73728
    s_mov_b32 m0, 29696
    s_nop 0
    buffer_load_dwordx4 v9, s[56:59], s48 offen nt lds
    s_waitcnt vmcnt(7)
    s_add_u32 s48, s46, 81920
    s_mov_b32 m0, 30720
    s_nop 0
    buffer_load_dwordx4 v9, s[56:59], s48 offen nt lds
    s_waitcnt vmcnt(7)
    s_add_u32 s48, s46, 90112
    s_mov_b32 m0, 31744
    s_nop 0
    buffer_load_dwordx4 v9, s[56:59], s48 offen nt lds
    s_waitcnt vmcnt(7)
    s_add_u32 s48, s46, 98304
    s_mov_b32 m0, 32768
    s_nop 0
    buffer_load_dwordx4 v9, s[56:59], s48 offen nt lds
    s_waitcnt vmcnt(7)
    s_add_u32 s48, s46, 106496
    s_mov_b32 m0, 33792
    s_nop 0
    buffer_load_dwordx4 v9, s[56:59], s48 offen nt lds
    s_waitcnt vmcnt(7)
    s_add_u32 s48, s46, 114688
    s_mov_b32 m0, 34816
    s_nop 0
    buffer_load_dwordx4 v9, s[56:59], s48 offen nt lds
    s_waitcnt vmcnt(7)
    s_add_u32 s48, s46, 122880
    s_mov_b32 m0, 35840
    s_nop 0
    buffer_load_dwordx4 v9, s[56:59], s48 offen nt lds
    s_waitcnt vmcnt(7)
    s_mov_b32 s48, 0
    buffer_load_dword v20, v18, s[60:63], s48 offen
    s_waitcnt vmcnt(7)
    s_mov_b32 s48, 0
    buffer_load_dword v20, v18, s[4:7], s48 offen
    s_waitcnt vmcnt(7)
    s_add_u32 s48, s47, 0
    buffer_load_dword v20, v19, s[8:11], s48 offen
    s_waitcnt vmcnt(3)
    s_mov_b64 exec, 1
    ds_write_b32 v13, v12 offset:2636
    s_mov_b64 exec, -1
    s_mov_b32 s48, 0
    s_mov_b32 m0, 36864
    s_nop 0
    buffer_load_dwordx4 v10, s[12:15], s48 offen nt lds
    s_waitcnt vmcnt(3)
    s_mov_b32 s48, 114688
    s_mov_b32 m0, 37888
    s_nop 0
    buffer_load_dwordx4 v10, s[12:15], s48 offen nt lds
    s_waitcnt vmcnt(3)
    s_mov_b32 s48, 229376
    s_mov_b32 m0, 38912
    s_nop 0
    buffer_load_dwordx4 v10, s[12:15], s48 offen nt lds
    s_waitcnt vmcnt(3)
    s_mov_b32 s48, 344064
    s_mov_b32 m0, 39936
    s_nop 0
    buffer_load_dwordx4 v10, s[12:15], s48 offen nt lds
    s_waitcnt vmcnt(3)
    s_mov_b32 s48, 458752
    s_mov_b32 m0, 40960
    s_nop 0
    buffer_load_dwordx4 v10, s[12:15], s48 offen nt lds
    s_waitcnt vmcnt(3)
    s_mov_b32 s48, 573440
    s_mov_b32 m0, 41984
    s_nop 0
    buffer_load_dwordx4 v10, s[12:15], s48 offen nt lds
    s_waitcnt vmcnt(3)
    s_mov_b32 s48, 688128
    s_mov_b32 m0, 43008
    s_nop 0
    buffer_load_dwordx4 v10, s[12:15], s48 offen nt lds
    s_waitcnt vmcnt(3)
    s_mov_b32 s48, 802816
    s_mov_b32 m0, 44032
    s_nop 0
    buffer_load_dwordx4 v10, s[12:15], s48 offen nt lds
    s_waitcnt vmcnt(3)
    s_mov_b32 s48, 917504
    s_mov_b32 m0, 45056
    s_nop 0
    buffer_load_dwordx4 v10, s[12:15], s48 offen nt lds
    s_waitcnt vmcnt(3)
    s_mov_b32 s48, 1032192
    s_mov_b32 m0, 46080
    s_nop 0
    buffer_load_dwordx4 v10, s[12:15], s48 offen nt lds
    s_waitcnt vmcnt(3)
    s_mov_b32 s48, 1146880
    s_mov_b32 m0, 47104
    s_nop 0
    buffer_load_dwordx4 v10, s[12:15], s48 offen nt lds
    s_waitcnt vmcnt(3)
    s_mov_b32 s48, 1261568
    s_mov_b32 m0, 48128
    s_nop 0
    buffer_load_dwordx4 v10, s[12:15], s48 offen nt lds
    s_waitcnt vmcnt(3)
    s_mov_b32 s48, 1376256
    s_mov_b32 m0, 49152
    s_nop 0
    buffer_load_dwordx4 v10, s[12:15], s48 offen nt lds
    s_waitcnt vmcnt(3)
    s_mov_b32 s48, 1490944
    s_mov_b32 m0, 50176
    s_nop 0
    buffer_load_dwordx4 v10, s[12:15], s48 offen nt lds
    s_waitcnt vmcnt(3)
    s_mov_b32 s48, 1605632
    s_mov_b32 m0, 51200
    s_nop 0
    buffer_load_dwordx4 v10, s[12:15], s48 offen nt lds
    s_waitcnt vmcnt(3)
    s_mov_b32 s48, 1720320
    s_mov_b32 m0, 52224
    s_nop 0
    buffer_load_dwordx4 v10, s[12:15], s48 offen nt lds
    s_waitcnt vmcnt(3)
    s_add_u32 s48, s47, 0
    s_mov_b32 m0, 53248
    s_nop 0
    buffer_load_dwordx4 v11, s[8:11], s48 offen nt lds
    s_waitcnt vmcnt(3)
    s_add_u32 s48, s47, 32768
    s_mov_b32 m0, 54272
    s_nop 0
    buffer_load_dwordx4 v11, s[8:11], s48 offen nt lds
    s_waitcnt vmcnt(3)
    s_add_u32 s48, s47, 65536
    s_mov_b32 m0, 55296
    s_nop 0
    buffer_load_dwordx4 v11, s[8:11], s48 offen nt lds
    s_waitcnt vmcnt(3)
    s_mov_b64 exec, 1
    ds_write_b32 v13, v12 offset:2640
    s_mov_b64 exec, -1
    s_add_u32 s48, s47, 98304
    s_mov_b32 m0, 56320
    s_nop 0
    buffer_load_dwordx4 v11, s[8:11], s48 offen nt lds
    s_waitcnt vmcnt(3)
    s_add_u32 s48, s47, 131072
    s_mov_b32 m0, 57344
    s_nop 0
    buffer_load_dwordx4 v11, s[8:11], s48 offen nt lds
    s_waitcnt vmcnt(3)
    s_add_u32 s48, s47, 163840
    s_mov_b32 m0, 58368
    s_nop 0
    buffer_load_dwordx4 v11, s[8:11], s48 offen nt lds
    s_waitcnt vmcnt(3)
    s_add_u32 s48, s47, 196608
    s_mov_b32 m0, 59392
    s_nop 0
    buffer_load_dwordx4 v11, s[8:11], s48 offen nt lds
    s_waitcnt vmcnt(3)
    s_add_u32 s48, s47, 229376
    s_mov_b32 m0, 60416
    s_nop 0
    buffer_load_dwordx4 v11, s[8:11], s48 offen nt lds
    s_waitcnt vmcnt(0)
    s_mov_b64 exec, 1
    ds_write_b32 v13, v12 offset:2644
    s_mov_b64 exec, -1
    s_waitcnt lgkmcnt(0)
    s_endpgm
L_AD:
    s_barrier
    s_cmp_ge_u32 s30, 4
    s_cbranch_scc1 L_D
    s_waitcnt lgkmcnt(0)
    s_load_dword s32, s[26:27], 393216
    v_mov_b32 v3, 1
    v_mov_b32 v4, 0
    v_mov_b32 v5, 0
    v_mov_b32 v15, 0
    v_and_b32 v24, 3, v1
    v_lshrrev_b32 v26, 4, v1
    v_mul_u32_u24 v25, 320, v24
    v_lshl_add_u32 v25, v26, 4, v25
    v_add_u32 v6, 0, v25
    v_lshlrev_b32 v25, 6, v26
    v_lshl_add_u32 v25, v24, 4, v25
    v_add_u32 v8, 1280, v25
    s_lshl_b32 s46, s31, 8
    v_add_u32 v7, s46, v8
    v_lshlrev_b32 v25, 4, v24
    v_add_u32 v10, 2304, v25
    s_lshl_b32 s46, s31, 2
    v_add_u32 v9, s46, v10
    v_and_b32 v25, 15, v1
    v_lshrrev_b32 v25, 2, v25
    v_and_b32 v27, 1, v26
    v_lshlrev_b32 v27, 3, v27
    v_lshl_add_u32 v27, v25, 1, v27
    v_lshl_add_u32 v25, v26, 2, v25
    v_lshlrev_b32 v25, 8, v25
    v_lshrrev_b32 v12, 1, v24
    s_lshl_b32 s46, s31, 2
    v_add_u32 v12, s46, v12
    v_xor_b32 v12, v12, v27
    v_lshl_add_u32 v25, v12, 4, v25
    v_and_b32 v27, 1, v24
    v_lshl_add_u32 v25, v27, 3, v25
    v_add_u32 v11, 61440, v25
    v_xor_b32 v12, 32, v25
    v_add_u32 v12, 61440, v12
    v_and_b32 v25, 15, v1
    v_xor_b32 v27, v25, v26
    v_lshlrev_b32 v27, 4, v27
    v_lshl_add_u32 v2, v25, 8, v27
    s_lshl_b32 s46, s28, 16
    s_lshl_b32 s47, s31, 14
    s_add_u32 s46, s46, s47
    s_lshl_b32 s47, s29, 6
    s_add_u32 s46, s46, s47
    s_add_u32 s46, s46, 524288
    v_lshlrev_b32 v25, 11, v26
    v_lshl_add_u32 v25, v24, 4, v25
    v_add_u32 v13, s46, v25
    v_and_b32 v25, 15, v1
    v_lshrrev_b32 v25, 1, v25
    s_lshl_b32 s46, s29, 3
    v_add_u32 v25, s46, v25
    v_lshrrev_b32 v27, 6, v25
    v_lshlrev_b32 v27, 14, v27
    v_and_b32 v25, 63, v25
    v_lshl_add_u32 v25, v25, 7, v27
    v_and_b32 v27, 1, v1
    v_lshl_add_u32 v27, v26, 1, v27
    v_lshlrev_b32 v27, 3, v27
    s_lshl_b32 s46, s31, 13
    s_add_u32 s46, s46, 131072
    v_add3_u32 v16, v25, v27, s46
    v_add_u32 v17, 2368, v27
    s_lshl_b32 s46, s29, 5
    v_lshrrev_b32 v27, 1, v27
    v_add_u32 v22, s46, v27
    global_load_dword v21, v22, s[4:5]
    s_lshl_b32 s46, s28, 13
    s_add_u32 s46, s46, 460800
    v_add_u32 v18, s46, v22
    v_add_u32 v19, 4096, v18
    s_mov_b32 s56, 0xffff0000
    s_mov_b32 s59, 0xffffff00
    v_mov_b32 v164, 1040356334
    v_mov_b32 v165, v164
    s_mov_b32 s52, 0x00030003
    s_mov_b32 s53, 0x00030003
    s_lshl_b32 s45, s28, 1
    s_lshl_b64 s[50:51], s[52:53], s45
    s_mov_b32 s54, 0x000f000f
    s_mov_b32 s55, 0x000f000f
    s_waitcnt lgkmcnt(0)
    s_add_u32 s33, s32, 1
    v_mov_b32 v23, s33
    v_and_b32 v14, 0xff, v23
    s_mov_b32 s44, 131072
L_wf_1:
    ds_read_b32 v24, v15 offset:2628
    s_waitcnt lgkmcnt(0)
    v_cmp_eq_u32 vcc, 0, v24
    s_cbranch_vccz L_ok_2
    s_sleep 2
    s_sub_u32 s44, s44, 1
    s_cbranch_scc0 L_wf_1
    s_mov_b32 s45, 30
    s_branch L_fail
L_ok_2:
    s_lshl_b32 s45, s31, 13
    s_add_u32 s45, s45, 94208
    v_xor_b32 v25, 0, v2
    v_add_u32 v25, s45, v25
    ds_read_b128 v[28:31], v25 offset:0
    ds_read_b128 v[44:47], v25 offset:4096
    v_xor_b32 v25, 64, v2
    v_add_u32 v25, s45, v25
    ds_read_b128 v[32:35], v25 offset:0
    ds_read_b128 v[48:51], v25 offset:4096
    v_xor_b32 v25, 128, v2
    v_add_u32 v25, s45, v25
    ds_read_b128 v[36:39], v25 offset:0
    ds_read_b128 v[52:55], v25 offset:4096
    v_xor_b32 v25, 192, v2
    v_add_u32 v25, s45, v25
    ds_read_b128 v[40:43], v25 offset:0
    ds_read_b128 v[56:59], v25 offset:4096
    s_waitcnt vmcnt(0)
    v_lshlrev_b32 v20, 16, v21
    v_and_b32 v21, s56, v21
    s_mov_b32 s44, 131072
L_wf_3:
    ds_read_b32 v24, v15 offset:2648
    s_waitcnt lgkmcnt(0)
    v_cmp_eq_u32 vcc, 0, v24
    s_cbranch_vccz L_ok_4
    s_sleep 1
    s_sub_u32 s44, s44, 1
    s_cbranch_scc0 L_wf_3
    s_mov_b32 s45, 31
    s_branch L_fail
L_ok_4:
    ds_read_b32 v24, v15 offset:2692
    s_waitcnt lgkmcnt(0)
    v_readfirstlane_b32 s34, v24
    s_branch L_A_q
L_A_loop:
    s_barrier
L_A_q:
    ds_read_b128 v[92:95], v6 offset:0
    ds_read_b128 v[96:99], v6 offset:64
    ds_read_b128 v[100:103], v6 offset:128
    ds_read_b128 v[104:107], v6 offset:192
    s_waitcnt lgkmcnt(0)
    v_mfma_f32_16x16x32_bf16 v[108:111], v[28:31], v[92:95], 0
    v_mfma_f32_16x16x32_bf16 v[112:115], v[44:47], v[92:95], 0
    v_mfma_f32_16x16x32_bf16 v[108:111], v[32:35], v[96:99], v[108:111]
    v_mfma_f32_16x16x32_bf16 v[112:115], v[48:51], v[96:99], v[112:115]
    v_mfma_f32_16x16x32_bf16 v[108:111], v[36:39], v[100:103], v[108:111]
    v_mfma_f32_16x16x32_bf16 v[112:115], v[52:55], v[100:103], v[112:115]
    v_mfma_f32_16x16x32_bf16 v[108:111], v[40:43], v[104:107], v[108:111]
    v_mfma_f32_16x16x32_bf16 v[112:115], v[56:59], v[104:107], v[112:115]
    s_nop 6
    v_max3_f32 v24, v108, v109, v110
    v_max3_f32 v25, v112, v113, v114
    v_max3_f32 v24, v24, v111, v115
    v_max_f32 v24, v24, v25
    v_mov_b32 v25, v24
    s_nop 1
    v_permlane16_swap_b32 v24, v25
    v_max_f32 v24, v24, v25
    v_mov_b32 v25, v24
    s_nop 1
    v_permlane32_swap_b32 v24, v25
    v_max_f32 v24, v24, v25
    v_mul_f32 v26, v164, v24
    v_mov_b32 v27, v26
    v_pk_fma_f32 v[108:109], v[108:109], v[164:165], v[26:27] neg_lo:[0,0,1] neg_hi:[0,0,1]
    v_pk_fma_f32 v[110:111], v[110:111], v[164:165], v[26:27] neg_lo:[0,0,1] neg_hi:[0,0,1]
    v_pk_fma_f32 v[112:113], v[112:113], v[164:165], v[26:27] neg_lo:[0,0,1] neg_hi:[0,0,1]
    v_pk_fma_f32 v[114:115], v[114:115], v[164:165], v[26:27] neg_lo:[0,0,1] neg_hi:[0,0,1]
    v_exp_f32 v108, v108
    v_exp_f32 v109, v109
    v_exp_f32 v110, v110
    v_exp_f32 v111, v111
    v_exp_f32 v112, v112
    v_exp_f32 v113, v113
    v_exp_f32 v114, v114
    v_exp_f32 v115, v115
    v_cvt_pk_bf16_f32 v116, v108, v109
    v_cvt_pk_bf16_f32 v117, v110, v111
    v_cvt_pk_bf16_f32 v118, v112, v113
    v_cvt_pk_bf16_f32 v119, v114, v115
    s_mov_b64 exec, s[54:55]
    ds_write_b128 v7, v[116:119]
    s_mov_b64 exec, 15
    ds_write_b32 v9, v26
    s_mov_b64 exec, -1
    s_cmp_eq_u32 s35, 0
    s_cbranch_scc1 L_pp0_5
    s_waitcnt lgkmcnt(0)
    s_barrier
    ds_read_b128 v[92:95], v8 offset:0
    ds_read_b128 v[96:99], v8 offset:256
    ds_read_b128 v[100:103], v8 offset:512
    ds_read_b128 v[104:107], v8 offset:768
    ds_read_b128 v[152:155], v10
    s_branch L_pp1_6
L_pp0_5:
    s_lshl_b32 s45, s31, 2
    v_mov_b32 v25, s45
    s_mov_b64 exec, 1
    ds_write_b32 v25, v3 offset:2656
    s_mov_b64 exec, -1
    s_mov_b32 s44, 131072
L_wf_7:
    ds_read_b128 v[152:155], v15 offset:2656
    s_waitcnt lgkmcnt(0)
    v_and_b32 v152, v152, v153
    v_and_b32 v154, v154, v155
    v_and_b32 v152, v152, v154
    v_cmp_eq_u32 vcc, 0, v152
    s_cbranch_vccz L_ok_8
    s_sub_u32 s44, s44, 1
    s_cbranch_scc0 L_wf_7
    s_mov_b32 s45, 32
    s_branch L_fail
L_ok_8:
    ds_read_b128 v[92:95], v8 offset:0
    ds_read_b128 v[96:99], v8 offset:256
    ds_read_b128 v[100:103], v8 offset:512
    ds_read_b128 v[104:107], v8 offset:768
    ds_read_b128 v[152:155], v10
    s_mov_b32 s44, 131072
L_wf_9:
    ds_read_b32 v24, v15 offset:2632
    s_waitcnt lgkmcnt(0)
    v_cmp_eq_u32 vcc, 0, v24
    s_cbranch_vccz L_ok_10
    s_sub_u32 s44, s44, 1
    s_cbranch_scc0 L_wf_9
    s_mov_b32 s45, 33
    s_branch L_fail
L_ok_10:
    ds_read_b64_tr_b16 v[60:61], v11 offset:0
    ds_read_b64_tr_b16 v[62:63], v11 offset:4096
    ds_read_b64_tr_b16 v[64:65], v11 offset:8192
    ds_read_b64_tr_b16 v[66:67], v11 offset:12288
    ds_read_b64_tr_b16 v[68:69], v11 offset:16384
    ds_read_b64_tr_b16 v[70:71], v11 offset:20480
    ds_read_b64_tr_b16 v[72:73], v11 offset:24576
    ds_read_b64_tr_b16 v[74:75], v11 offset:28672
    ds_read_b64_tr_b16 v[76:77], v12 offset:0
    ds_read_b64_tr_b16 v[78:79], v12 offset:4096
    ds_read_b64_tr_b16 v[80:81], v12 offset:8192
    ds_read_b64_tr_b16 v[82:83], v12 offset:12288
    ds_read_b64_tr_b16 v[84:85], v12 offset:16384
    ds_read_b64_tr_b16 v[86:87], v12 offset:20480
    ds_read_b64_tr_b16 v[88:89], v12 offset:24576
    ds_read_b64_tr_b16 v[90:91], v12 offset:28672
L_pp1_6:
    v_add_u32 v25, 8192, v13
    s_waitcnt lgkmcnt(0)
    v_mfma_f32_16x16x32_bf16 v[120:123], v[60:63], v[92:95], 0
    v_max3_f32 v24, v152, v153, v154
    v_max_f32 v24, v24, v155
    v_mfma_f32_16x16x32_bf16 v[136:139], v[76:79], v[92:95], 0
    v_sub_f32 v156, v152, v24
    v_sub_f32 v157, v153, v24
    v_mfma_f32_16x16x32_bf16 v[124:127], v[64:67], v[96:99], 0
    v_exp_f32 v156, v156
    v_exp_f32 v157, v157
    v_mfma_f32_16x16x32_bf16 v[140:143], v[80:83], v[96:99], 0
    v_sub_f32 v158, v154, v24
    v_sub_f32 v159, v155, v24
    v_mfma_f32_16x16x32_bf16 v[128:131], v[68:71], v[100:103], 0
    v_exp_f32 v158, v158
    v_exp_f32 v159, v159
    v_mfma_f32_16x16x32_bf16 v[144:147], v[84:87], v[100:103], 0
    v_pk_mul_f32 v[108:109], v[120:121], v[156:157] op_sel:[0,0] op_sel_hi:[1,0]
    v_pk_mul_f32 v[110:111], v[122:123], v[156:157] op_sel:[0,0] op_sel_hi:[1,0]
    v_mfma_f32_16x16x32_bf16 v[132:135], v[72:75], v[104:107], 0
    v_pk_mul_f32 v[112:113], v[136:137], v[156:157] op_sel:[0,0] op_sel_hi:[1,0]
    v_pk_mul_f32 v[114:115], v[138:139], v[156:157] op_sel:[0,0] op_sel_hi:[1,0]
    v_mfma_f32_16x16x32_bf16 v[148:151], v[88:91], v[104:107], 0
    v_pk_fma_f32 v[108:109], v[124:125], v[156:157], v[108:109] op_sel:[0,1,0] op_sel_hi:[1,1,1]
    v_pk_fma_f32 v[110:111], v[126:127], v[156:157], v[110:111] op_sel:[0,1,0] op_sel_hi:[1,1,1]
    v_pk_fma_f32 v[112:113], v[140:141], v[156:157], v[112:113] op_sel:[0,1,0] op_sel_hi:[1,1,1]
    v_pk_fma_f32 v[114:115], v[142:143], v[156:157], v[114:115] op_sel:[0,1,0] op_sel_hi:[1,1,1]
    v_pk_fma_f32 v[108:109], v[128:129], v[158:159], v[108:109] op_sel:[0,0,0] op_sel_hi:[1,0,1]
    v_pk_fma_f32 v[110:111], v[130:131], v[158:159], v[110:111] op_sel:[0,0,0] op_sel_hi:[1,0,1]
    v_pk_fma_f32 v[112:113], v[144:145], v[158:159], v[112:113] op_sel:[0,0,0] op_sel_hi:[1,0,1]
    v_pk_fma_f32 v[114:115], v[146:147], v[158:159], v[114:115] op_sel:[0,0,0] op_sel_hi:[1,0,1]
    v_pk_fma_f32 v[108:109], v[132:133], v[158:159], v[108:109] op_sel:[0,1,0] op_sel_hi:[1,1,1]
    v_pk_fma_f32 v[110:111], v[134:135], v[158:159], v[110:111] op_sel:[0,1,0] op_sel_hi:[1,1,1]
    v_pk_fma_f32 v[112:113], v[148:149], v[158:159], v[112:113] op_sel:[0,1,0] op_sel_hi:[1,1,1]
    v_pk_fma_f32 v[114:115], v[150:151], v[158:159], v[114:115] op_sel:[0,1,0] op_sel_hi:[1,1,1]
    v_and_or_b32 v108, v108, s59, v14
    v_and_or_b32 v109, v109, s59, v14
    v_and_or_b32 v110, v110, s59, v14
    v_and_or_b32 v111, v111, s59, v14
    v_and_or_b32 v112, v112, s59, v14
    v_and_or_b32 v113, v113, s59, v14
    v_and_or_b32 v114, v114, s59, v14
    v_and_or_b32 v115, v115, s59, v14
    s_mov_b64 exec, s[54:55]
    s_cmp_lg_u32 s34, 0
    s_cbranch_scc1 L_slow_11
    global_store_dwordx4 v13, v[108:111], s[26:27]
L_ret_12:
    s_cmp_lg_u32 s34, 0
    s_cbranch_scc1 L_slow_13
    global_store_dwordx4 v25, v[112:115], s[26:27]
L_ret_14:
    s_mov_b64 exec, -1
    s_cmp_ge_u32 s31, 2
    s_cbranch_scc1 L_anext_15
    s_mov_b32 s44, 131072
L_wf_16:
    ds_read_b32 v120, v4 offset:2696
    ds_read_b64 v[160:161], v17 offset:0
    s_waitcnt lgkmcnt(0)
    v_cmp_eq_u32 vcc, 0, v120
    s_cbranch_vccz L_ok_17
    s_sleep 1
    s_sub_u32 s44, s44, 1
    s_cbranch_scc0 L_wf_16
    s_mov_b32 s45, 20
    s_branch L_fail
L_ok_17:
    v_xor_b32 v160, v160, v14
    v_xor_b32 v161, v161, v14
    s_not_b64 exec, s[50:51]
    s_mov_b32 s44, 131072
    global_load_dwordx2 v[124:125], v16, s[26:27] sc1
    s_sleep 2
    global_load_dwordx2 v[126:127], v16, s[26:27] sc1
    s_sleep 2
    global_load_dwordx2 v[128:129], v16, s[26:27] sc1
    s_sleep 2
L_cgr_18:
    global_load_dwordx2 v[130:131], v16, s[26:27] sc1
    s_sleep 2
    s_waitcnt vmcnt(3)
    v_xor_b32 v160, v124, v14
    v_xor_b32 v161, v125, v14
    v_or_b32 v162, v160, v161
    v_and_b32 v162, 0xff, v162
    v_cmp_ne_u32 vcc, 0, v162
    s_cbranch_vccz L_ok_19
    global_load_dwordx2 v[124:125], v16, s[26:27] sc1
    s_sleep 2
    s_waitcnt vmcnt(3)
    v_xor_b32 v160, v126, v14
    v_xor_b32 v161, v127, v14
    v_or_b32 v162, v160, v161
    v_and_b32 v162, 0xff, v162
    v_cmp_ne_u32 vcc, 0, v162
    s_cbranch_vccz L_ok_19
    global_load_dwordx2 v[126:127], v16, s[26:27] sc1
    s_sleep 2
    s_waitcnt vmcnt(3)
    v_xor_b32 v160, v128, v14
    v_xor_b32 v161, v129, v14
    v_or_b32 v162, v160, v161
    v_and_b32 v162, 0xff, v162
    v_cmp_ne_u32 vcc, 0, v162
    s_cbranch_vccz L_ok_19
    global_load_dwordx2 v[128:129], v16, s[26:27] sc1
    s_sleep 2
    s_waitcnt vmcnt(3)
    v_xor_b32 v160, v130, v14
    v_xor_b32 v161, v131, v14
    v_or_b32 v162, v160, v161
    v_and_b32 v162, 0xff, v162
    v_cmp_ne_u32 vcc, 0, v162
    s_cbranch_vccz L_ok_19
    s_sub_u32 s44, s44, 1
    s_cbranch_scc0 L_cgr_18
    s_mov_b32 s45, 21
    s_branch L_fail
L_ok_19:
    s_mov_b64 exec, -1
    v_add_f32_dpp v160, v160, v160 row_ror:2 row_mask:0xf bank_mask:0xf
    v_add_f32_dpp v161, v161, v161 row_ror:2 row_mask:0xf bank_mask:0xf
    s_nop 0
    v_add_f32_dpp v160, v160, v160 row_ror:4 row_mask:0xf bank_mask:0xf
    v_add_f32_dpp v161, v161, v161 row_ror:4 row_mask:0xf bank_mask:0xf
    s_nop 0
    v_add_f32_dpp v160, v160, v160 row_ror:8 row_mask:0xf bank_mask:0xf
    v_add_f32_dpp v161, v161, v161 row_ror:8 row_mask:0xf bank_mask:0xf
    v_add_f32 v160, v160, v20
    v_add_f32 v161, v161, v21
    v_cvt_pk_bf16_f32 v26, v160, v161
    v_min_u32 v160, 0xfffffffe, v26
    s_mov_b64 exec, s[52:53]
    s_cmp_lg_u32 s34, 0
    s_cbranch_scc1 L_slow_20
    global_store_dword v18, v160, s[26:27]
L_ret_21:
    s_mov_b64 exec, -1
    v_lshlrev_b32 v20, 16, v26
    v_and_b32 v21, s56, v26
    s_mov_b64 exec, 1
    ds_write_b32 v4, v3 offset:2680
    s_mov_b64 exec, -1
    s_add_u32 s45, s31, 1
    v_mov_b32 v24, s45
    v_add_u32 v25, 2720, v4
    s_mov_b64 exec, 1
    ds_cmpst_b32 v25, v15, v24
    s_mov_b64 exec, -1
    s_cmp_lg_u32 s35, 0
    s_cbranch_scc1 L_afin_22
    v_add_u32 v163, 65536, v16
    s_mov_b32 s44, 131072
L_wf_23:
    ds_read_b32 v120, v4 offset:2704
    ds_read_b64 v[160:161], v17 offset:64
    s_waitcnt lgkmcnt(0)
    v_cmp_eq_u32 vcc, 0, v120
    s_cbranch_vccz L_ok_24
    s_sleep 1
    s_sub_u32 s44, s44, 1
    s_cbranch_scc0 L_wf_23
    s_mov_b32 s45, 22
    s_branch L_fail
L_ok_24:
    v_xor_b32 v160, v160, v14
    v_xor_b32 v161, v161, v14
    s_not_b64 exec, s[50:51]
    s_mov_b32 s44, 131072
    global_load_dwordx2 v[124:125], v163, s[26:27] sc1
    s_sleep 2
    global_load_dwordx2 v[126:127], v163, s[26:27] sc1
    s_sleep 2
    global_load_dwordx2 v[128:129], v163, s[26:27] sc1
    s_sleep 2
L_cgr_25:
    global_load_dwordx2 v[130:131], v163, s[26:27] sc1
    s_sleep 2
    s_waitcnt vmcnt(3)
    v_xor_b32 v160, v124, v14
    v_xor_b32 v161, v125, v14
    v_or_b32 v162, v160, v161
    v_and_b32 v162, 0xff, v162
    v_cmp_ne_u32 vcc, 0, v162
    s_cbranch_vccz L_ok_26
    global_load_dwordx2 v[124:125], v163, s[26:27] sc1
    s_sleep 2
    s_waitcnt vmcnt(3)
    v_xor_b32 v160, v126, v14
    v_xor_b32 v161, v127, v14
    v_or_b32 v162, v160, v161
    v_and_b32 v162, 0xff, v162
    v_cmp_ne_u32 vcc, 0, v162
    s_cbranch_vccz L_ok_26
    global_load_dwordx2 v[126:127], v163, s[26:27] sc1
    s_sleep 2
    s_waitcnt vmcnt(3)
    v_xor_b32 v160, v128, v14
    v_xor_b32 v161, v129, v14
    v_or_b32 v162, v160, v161
    v_and_b32 v162, 0xff, v162
    v_cmp_ne_u32 vcc, 0, v162
    s_cbranch_vccz L_ok_26
    global_load_dwordx2 v[128:129], v163, s[26:27] sc1
    s_sleep 2
    s_waitcnt vmcnt(3)
    v_xor_b32 v160, v130, v14
    v_xor_b32 v161, v131, v14
    v_or_b32 v162, v160, v161
    v_and_b32 v162, 0xff, v162
    v_cmp_ne_u32 vcc, 0, v162
    s_cbranch_vccz L_ok_26
    s_sub_u32 s44, s44, 1
    s_cbranch_scc0 L_cgr_25
    s_mov_b32 s45, 23
    s_branch L_fail
L_ok_26:
    s_mov_b64 exec, -1
    v_add_f32_dpp v160, v160, v160 row_ror:2 row_mask:0xf bank_mask:0xf
    v_add_f32_dpp v161, v161, v161 row_ror:2 row_mask:0xf bank_mask:0xf
    s_nop 0
    v_add_f32_dpp v160, v160, v160 row_ror:4 row_mask:0xf bank_mask:0xf
    v_add_f32_dpp v161, v161, v161 row_ror:4 row_mask:0xf bank_mask:0xf
    s_nop 0
    v_add_f32_dpp v160, v160, v160 row_ror:8 row_mask:0xf bank_mask:0xf
    v_add_f32_dpp v161, v161, v161 row_ror:8 row_mask:0xf bank_mask:0xf
    v_add_f32 v160, v160, v20
    v_add_f32 v161, v161, v21
    v_cvt_pk_bf16_f32 v26, v160, v161
    v_min_u32 v160, 0xfffffffe, v26
    s_mov_b64 exec, s[52:53]
    s_cmp_lg_u32 s34, 0
    s_cbranch_scc1 L_slow_27
    global_store_dword v19, v160, s[26:27]
L_ret_28:
    s_mov_b64 exec, -1
    v_lshlrev_b32 v20, 16, v26
    v_and_b32 v21, s56, v26
    s_mov_b64 exec, 1
    ds_write_b32 v15, v3 offset:2688
    s_mov_b64 exec, -1
L_anext_15:
    s_cmp_lg_u32 s35, 0
    s_cbranch_scc1 L_A_end
    s_mov_b32 s35, 1
    s_add_u32 s33, s33, 1
    v_mov_b32 v23, s33
    v_and_b32 v14, 0xff, v23
    v_add_u32 v16, 0x20000, v16
    v_add_u32 v17, 128, v17
    v_mov_b32 v4, 4
    v_mov_b32 v5, 32
    v_add_u32 v18, 1024, v18
    s_waitcnt vmcnt(0)
    s_branch L_A_loop
L_afin_22:
    s_cmp_lg_u32 s28, 0
    s_cbranch_scc1 L_A_end
    ds_read_b32 v24, v4 offset:2720
    s_add_u32 s45, s31, 1
    s_waitcnt lgkmcnt(0)
    v_readfirstlane_b32 s46, v24
    s_cmp_lg_u32 s45, s46
    s_cbranch_scc1 L_A_end
    v_add_u32 v163, 65536, v16
    s_mov_b32 s44, 131072
L_wf_29:
    ds_read_b32 v120, v4 offset:2704
    ds_read_b64 v[160:161], v17 offset:64
    s_waitcnt lgkmcnt(0)
    v_cmp_eq_u32 vcc, 0, v120
    s_cbranch_vccz L_ok_30
    s_sleep 1
    s_sub_u32 s44, s44, 1
    s_cbranch_scc0 L_wf_29
    s_mov_b32 s45, 24
    s_branch L_fail
L_ok_30:
    v_xor_b32 v160, v160, v14
    v_xor_b32 v161, v161, v14
    s_not_b64 exec, s[50:51]
    s_mov_b32 s44, 131072
    global_load_dwordx2 v[124:125], v163, s[26:27] sc1
    s_sleep 2
    global_load_dwordx2 v[126:127], v163, s[26:27] sc1
    s_sleep 2
    global_load_dwordx2 v[128:129], v163, s[26:27] sc1
    s_sleep 2
L_cgr_31:
    global_load_dwordx2 v[130:131], v163, s[26:27] sc1
    s_sleep 2
    s_waitcnt vmcnt(3)
    v_xor_b32 v160, v124, v14
    v_xor_b32 v161, v125, v14
    v_or_b32 v162, v160, v161
    v_and_b32 v162, 0xff, v162
    v_cmp_ne_u32 vcc, 0, v162
    s_cbranch_vccz L_ok_32
    global_load_dwordx2 v[124:125], v163, s[26:27] sc1
    s_sleep 2
    s_waitcnt vmcnt(3)
    v_xor_b32 v160, v126, v14
    v_xor_b32 v161, v127, v14
    v_or_b32 v162, v160, v161
    v_and_b32 v162, 0xff, v162
    v_cmp_ne_u32 vcc, 0, v162
    s_cbranch_vccz L_ok_32
    global_load_dwordx2 v[126:127], v163, s[26:27] sc1
    s_sleep 2
    s_waitcnt vmcnt(3)
    v_xor_b32 v160, v128, v14
    v_xor_b32 v161, v129, v14
    v_or_b32 v162, v160, v161
    v_and_b32 v162, 0xff, v162
    v_cmp_ne_u32 vcc, 0, v162
    s_cbranch_vccz L_ok_32
    global_load_dwordx2 v[128:129], v163, s[26:27] sc1
    s_sleep 2
    s_waitcnt vmcnt(3)
    v_xor_b32 v160, v130, v14
    v_xor_b32 v161, v131, v14
    v_or_b32 v162, v160, v161
    v_and_b32 v162, 0xff, v162
    v_cmp_ne_u32 vcc, 0, v162
    s_cbranch_vccz L_ok_32
    s_sub_u32 s44, s44, 1
    s_cbranch_scc0 L_cgr_31
    s_mov_b32 s45, 25
    s_branch L_fail
L_ok_32:
    s_mov_b64 exec, -1
    v_add_f32_dpp v160, v160, v160 row_ror:2 row_mask:0xf bank_mask:0xf
    v_add_f32_dpp v161, v161, v161 row_ror:2 row_mask:0xf bank_mask:0xf
    s_nop 0
    v_add_f32_dpp v160, v160, v160 row_ror:4 row_mask:0xf bank_mask:0xf
    v_add_f32_dpp v161, v161, v161 row_ror:4 row_mask:0xf bank_mask:0xf
    s_nop 0
    v_add_f32_dpp v160, v160, v160 row_ror:8 row_mask:0xf bank_mask:0xf
    v_add_f32_dpp v161, v161, v161 row_ror:8 row_mask:0xf bank_mask:0xf
    v_add_f32 v160, v160, v20
    v_add_f32 v161, v161, v21
    v_cvt_pk_bf16_f32 v24, v160, v161
    s_mov_b64 exec, s[52:53]
    global_store_dword v22, v24, s[22:23]
    s_mov_b64 exec, -1
    s_mov_b64 exec, 1
    ds_write_b32 v15, v3 offset:2652
    s_mov_b64 exec, -1
    s_cmp_lg_u32 s2, 0
    s_cbranch_scc1 L_A_end
    s_mov_b64 exec, 1
    v_mov_b32 v25, 393216
    global_store_dword v25, v23, s[26:27]
L_A_end:
    s_mov_b64 exec, -1
    s_endpgm
L_D:
    s_cmp_eq_u32 s31, 1
    s_cbranch_scc1 L_D1
    s_cmp_eq_u32 s31, 2
    s_cbranch_scc1 L_D2
    s_cmp_eq_u32 s31, 3
    s_cbranch_scc1 L_D3
    s_waitcnt lgkmcnt(0)
    s_load_dword s32, s[26:27], 393216
    v_mov_b32 v2, 0
    v_mov_b32 v3, 1
    v_mov_b32 v4, 0
    v_mov_b32 v5, 0x3f803f80
    v_lshrrev_b32 v8, 4, v1
    v_and_b32 v9, 3, v1
    v_and_b32 v10, 15, v1
    v_lshrrev_b32 v10, 2, v10
    s_mov_b32 s56, 0xffff0000
    s_mov_b32 s57, 0x07060302
    s_mov_b32 s59, 0xffffff00
    s_lshl_b32 s45, s28, 13
    s_lshl_b32 s46, s29, 8
    s_add_u32 s45, s45, s46
    s_add_u32 s45, s45, 458752
    v_lshlrev_b32 v20, 4, v1
    v_add_u32 v23, s45, v20
    v_mov_b32 v128, -1
    v_mov_b32 v129, -1
    v_mov_b32 v130, -1
    v_mov_b32 v131, -1
    s_mov_b64 exec, 0xffff
    global_store_dwordx4 v23, v[128:131], s[26:27] sc1
    s_mov_b64 exec, -1
    global_load_dwordx4 v[96:99], v20, s[4:5]
    s_lshl_b32 s45, s28, 11
    s_and_b32 s46, s29, 15
    s_lshl_b32 s46, s46, 7
    s_add_u32 s45, s45, s46
    v_lshlrev_b32 v21, 14, v1
    v_add_u32 v21, s45, v21
    s_mov_b64 exec, 3
    global_load_dword v11, v21, s[26:27] sc1
    s_mov_b64 exec, -1
    v_lshlrev_b32 v12, 12, v8
    v_lshl_add_u32 v12, v10, 5, v12
    v_lshl_add_u32 v12, v9, 3, v12
    s_lshl_b32 s45, s28, 13
    s_add_u32 s45, s45, 458752
    v_add_u32 v13, s45, v20
    v_add_u32 v13, 4096, v13
    s_lshl_b32 s46, s29, 5
    s_add_u32 s46, s46, s45
    s_add_u32 s46, s46, 7168
    v_lshlrev_b32 v16, 1, v1
    v_add_u32 v16, s46, v16
    s_lshl_b32 s45, s28, 11
    v_lshlrev_b32 v14, 5, v1
    v_add_u32 v14, s45, v14
    s_lshl_b32 s46, s29, 6
    s_add_u32 s46, s46, s45
    v_lshlrev_b32 v15, 2, v1
    v_add_u32 v15, s46, v15
    v_mul_u32_u24 v21, 320, v8
    v_and_b32 v22, 15, v1
    v_lshl_add_u32 v21, v22, 4, v21
    v_add_u32 v17, 0, v21
    v_mov_b32 v28, v5
    v_mov_b32 v29, v5
    s_waitcnt lgkmcnt(0)
    s_add_u32 s33, s32, 1
    v_mov_b32 v6, s33
    v_and_b32 v7, 0xff, v6
    v_and_b32 v18, 0xffff, v6
    s_getreg_b32 s48, hwreg(HW_REG_XCC_ID, 0, 4)
    s_lshl_b32 s48, s48, 12
    v_xor_b32 v19, s48, v18
    s_waitcnt vmcnt(0)
    s_lshl_b32 s45, s28, 13
    s_lshl_b32 s46, s29, 8
    s_add_u32 s45, s45, s46
    s_add_u32 s45, s45, 458752
    v_lshlrev_b32 v20, 7, v1
    v_add_u32 v20, s45, v20
    s_mov_b64 exec, 3
    global_load_dword v11, v20, s[26:27] sc1
    s_mov_b64 exec, -1
    s_mov_b32 s44, 131072
L_wf_33:
    ds_read_b32 v100, v2 offset:2624
    s_waitcnt lgkmcnt(0)
    v_cmp_eq_u32 vcc, 0, v100
    s_cbranch_vccz L_ok_34
    s_sleep 1
    s_sub_u32 s44, s44, 1
    s_cbranch_scc0 L_wf_33
    s_mov_b32 s45, 1
    s_branch L_fail
L_ok_34:
    ds_read_b64_tr_b16 v[30:31], v12 offset:4096
    ds_read_b64_tr_b16 v[32:33], v12 offset:4352
    ds_read_b64_tr_b16 v[34:35], v12 offset:4608
    ds_read_b64_tr_b16 v[36:37], v12 offset:4864
    ds_read_b64_tr_b16 v[38:39], v12 offset:4224
    ds_read_b64_tr_b16 v[40:41], v12 offset:4480
    ds_read_b64_tr_b16 v[42:43], v12 offset:4736
    ds_read_b64_tr_b16 v[44:45], v12 offset:4992
    ds_read_b64_tr_b16 v[46:47], v12 offset:5120
    ds_read_b64_tr_b16 v[48:49], v12 offset:5376
    ds_read_b64_tr_b16 v[50:51], v12 offset:5632
    ds_read_b64_tr_b16 v[52:53], v12 offset:5888
    ds_read_b64_tr_b16 v[54:55], v12 offset:5248
    ds_read_b64_tr_b16 v[56:57], v12 offset:5504
    ds_read_b64_tr_b16 v[58:59], v12 offset:5760
    ds_read_b64_tr_b16 v[60:61], v12 offset:6016
    ds_read_b64_tr_b16 v[62:63], v12 offset:6144
    ds_read_b64_tr_b16 v[64:65], v12 offset:6400
    ds_read_b64_tr_b16 v[66:67], v12 offset:6656
    ds_read_b64_tr_b16 v[68:69], v12 offset:6912
    ds_read_b64_tr_b16 v[70:71], v12 offset:6272
    ds_read_b64_tr_b16 v[72:73], v12 offset:6528
    ds_read_b64_tr_b16 v[74:75], v12 offset:6784
    ds_read_b64_tr_b16 v[76:77], v12 offset:7040
    ds_read_b64_tr_b16 v[78:79], v12 offset:7168
    ds_read_b64_tr_b16 v[80:81], v12 offset:7424
    ds_read_b64_tr_b16 v[82:83], v12 offset:7680
    ds_read_b64_tr_b16 v[84:85], v12 offset:7936
    ds_read_b64_tr_b16 v[86:87], v12 offset:7296
    ds_read_b64_tr_b16 v[88:89], v12 offset:7552
    ds_read_b64_tr_b16 v[90:91], v12 offset:7808
    ds_read_b64_tr_b16 v[92:93], v12 offset:8064
    s_waitcnt lgkmcnt(0)
    v_mfma_f32_4x4x4_16b_bf16 v[112:115], v[28:29], v[30:31], 0 cbsz:2 abid:0
    v_mfma_f32_4x4x4_16b_bf16 v[116:119], v[28:29], v[32:33], 0 cbsz:2 abid:0
    v_mfma_f32_4x4x4_16b_bf16 v[120:123], v[28:29], v[34:35], 0 cbsz:2 abid:0
    v_mfma_f32_4x4x4_16b_bf16 v[124:127], v[28:29], v[36:37], 0 cbsz:2 abid:0
    v_mfma_f32_4x4x4_16b_bf16 v[112:115], v[28:29], v[38:39], v[112:115] cbsz:2 abid:0
    v_mfma_f32_4x4x4_16b_bf16 v[116:119], v[28:29], v[40:41], v[116:119] cbsz:2 abid:0
    v_mfma_f32_4x4x4_16b_bf16 v[120:123], v[28:29], v[42:43], v[120:123] cbsz:2 abid:0
    v_mfma_f32_4x4x4_16b_bf16 v[124:127], v[28:29], v[44:45], v[124:127] cbsz:2 abid:0
    v_mfma_f32_4x4x4_16b_bf16 v[112:115], v[28:29], v[46:47], v[112:115] cbsz:2 abid:1
    v_mfma_f32_4x4x4_16b_bf16 v[116:119], v[28:29], v[48:49], v[116:119] cbsz:2 abid:1
    v_mfma_f32_4x4x4_16b_bf16 v[120:123], v[28:29], v[50:51], v[120:123] cbsz:2 abid:1
    v_mfma_f32_4x4x4_16b_bf16 v[124:127], v[28:29], v[52:53], v[124:127] cbsz:2 abid:1
    v_mfma_f32_4x4x4_16b_bf16 v[112:115], v[28:29], v[54:55], v[112:115] cbsz:2 abid:1
    v_mfma_f32_4x4x4_16b_bf16 v[116:119], v[28:29], v[56:57], v[116:119] cbsz:2 abid:1
    v_mfma_f32_4x4x4_16b_bf16 v[120:123], v[28:29], v[58:59], v[120:123] cbsz:2 abid:1
    v_mfma_f32_4x4x4_16b_bf16 v[124:127], v[28:29], v[60:61], v[124:127] cbsz:2 abid:1
    v_mfma_f32_4x4x4_16b_bf16 v[112:115], v[28:29], v[62:63], v[112:115] cbsz:2 abid:2
    v_mfma_f32_4x4x4_16b_bf16 v[116:119], v[28:29], v[64:65], v[116:119] cbsz:2 abid:2
    v_mfma_f32_4x4x4_16b_bf16 v[120:123], v[28:29], v[66:67], v[120:123] cbsz:2 abid:2
    v_mfma_f32_4x4x4_16b_bf16 v[124:127], v[28:29], v[68:69], v[124:127] cbsz:2 abid:2
    v_mfma_f32_4x4x4_16b_bf16 v[112:115], v[28:29], v[70:71], v[112:115] cbsz:2 abid:2
    v_mfma_f32_4x4x4_16b_bf16 v[116:119], v[28:29], v[72:73], v[116:119] cbsz:2 abid:2
    v_mfma_f32_4x4x4_16b_bf16 v[120:123], v[28:29], v[74:75], v[120:123] cbsz:2 abid:2
    v_mfma_f32_4x4x4_16b_bf16 v[124:127], v[28:29], v[76:77], v[124:127] cbsz:2 abid:2
    v_mfma_f32_4x4x4_16b_bf16 v[112:115], v[28:29], v[78:79], v[112:115] cbsz:2 abid:3
    v_mfma_f32_4x4x4_16b_bf16 v[116:119], v[28:29], v[80:81], v[116:119] cbsz:2 abid:3
    v_mfma_f32_4x4x4_16b_bf16 v[120:123], v[28:29], v[82:83], v[120:123] cbsz:2 abid:3
    v_mfma_f32_4x4x4_16b_bf16 v[124:127], v[28:29], v[84:85], v[124:127] cbsz:2 abid:3
    v_mfma_f32_4x4x4_16b_bf16 v[112:115], v[28:29], v[86:87], v[112:115] cbsz:2 abid:3
    v_mfma_f32_4x4x4_16b_bf16 v[116:119], v[28:29], v[88:89], v[116:119] cbsz:2 abid:3
    v_mfma_f32_4x4x4_16b_bf16 v[120:123], v[28:29], v[90:91], v[120:123] cbsz:2 abid:3
    v_mfma_f32_4x4x4_16b_bf16 v[124:127], v[28:29], v[92:93], v[124:127] cbsz:2 abid:3
    s_nop 2
    v_add_f32 v24, v112, v116
    s_nop 0
    v_add_f32 v20, v120, v124
    v_add_f32 v24, v24, v20
    v_mov_b32 v20, v24
    s_nop 1
    v_permlane16_swap_b32 v24, v20
    v_add_f32 v24, v24, v20
    v_mov_b32 v20, v24
    s_nop 1
    v_permlane32_swap_b32 v24, v20
    v_add_f32 v24, v24, v20
L_D0_loop:
    v_mfma_f32_4x4x4_16b_bf16 v[112:115], v[96:97], v[30:31], 0 cbsz:2 abid:0
    v_dot2_f32_bf16 v26, v96, v5, 0
    v_mfma_f32_4x4x4_16b_bf16 v[116:119], v[96:97], v[32:33], 0 cbsz:2 abid:0
    v_dot2_f32_bf16 v27, v96, v96, 0
    v_mfma_f32_4x4x4_16b_bf16 v[120:123], v[96:97], v[34:35], 0 cbsz:2 abid:0
    v_dot2_f32_bf16 v26, v97, v5, v26
    v_mfma_f32_4x4x4_16b_bf16 v[124:127], v[96:97], v[36:37], 0 cbsz:2 abid:0
    v_dot2_f32_bf16 v27, v97, v97, v27
    v_mfma_f32_4x4x4_16b_bf16 v[112:115], v[98:99], v[38:39], v[112:115] cbsz:2 abid:0
    v_dot2_f32_bf16 v26, v98, v5, v26
    v_mfma_f32_4x4x4_16b_bf16 v[116:119], v[98:99], v[40:41], v[116:119] cbsz:2 abid:0
    v_dot2_f32_bf16 v27, v98, v98, v27
    v_mfma_f32_4x4x4_16b_bf16 v[120:123], v[98:99], v[42:43], v[120:123] cbsz:2 abid:0
    v_dot2_f32_bf16 v26, v99, v5, v26
    v_mfma_f32_4x4x4_16b_bf16 v[124:127], v[98:99], v[44:45], v[124:127] cbsz:2 abid:0
    v_dot2_f32_bf16 v27, v99, v99, v27
    v_mfma_f32_4x4x4_16b_bf16 v[112:115], v[96:97], v[46:47], v[112:115] cbsz:2 abid:1
    v_mfma_f32_4x4x4_16b_bf16 v[116:119], v[96:97], v[48:49], v[116:119] cbsz:2 abid:1
    s_nop 0
    v_permlane32_swap_b32 v26, v27
    v_mfma_f32_4x4x4_16b_bf16 v[120:123], v[96:97], v[50:51], v[120:123] cbsz:2 abid:1
    v_add_f32 v26, v26, v27
    v_mfma_f32_4x4x4_16b_bf16 v[124:127], v[96:97], v[52:53], v[124:127] cbsz:2 abid:1
    v_mfma_f32_4x4x4_16b_bf16 v[112:115], v[98:99], v[54:55], v[112:115] cbsz:2 abid:1
    v_add_f32_dpp v26, v26, v26 row_ror:1 row_mask:0xf bank_mask:0xf
    v_mfma_f32_4x4x4_16b_bf16 v[116:119], v[98:99], v[56:57], v[116:119] cbsz:2 abid:1
    v_mfma_f32_4x4x4_16b_bf16 v[120:123], v[98:99], v[58:59], v[120:123] cbsz:2 abid:1
    v_add_f32_dpp v26, v26, v26 row_ror:2 row_mask:0xf bank_mask:0xf
    v_mfma_f32_4x4x4_16b_bf16 v[124:127], v[98:99], v[60:61], v[124:127] cbsz:2 abid:1
    v_mfma_f32_4x4x4_16b_bf16 v[112:115], v[96:97], v[62:63], v[112:115] cbsz:2 abid:2
    v_add_f32_dpp v26, v26, v26 row_ror:4 row_mask:0xf bank_mask:0xf
    v_mfma_f32_4x4x4_16b_bf16 v[116:119], v[96:97], v[64:65], v[116:119] cbsz:2 abid:2
    v_mfma_f32_4x4x4_16b_bf16 v[120:123], v[96:97], v[66:67], v[120:123] cbsz:2 abid:2
    v_add_f32_dpp v26, v26, v26 row_ror:8 row_mask:0xf bank_mask:0xf
    v_mfma_f32_4x4x4_16b_bf16 v[124:127], v[96:97], v[68:69], v[124:127] cbsz:2 abid:2
    v_mov_b32 v21, v26
    v_mfma_f32_4x4x4_16b_bf16 v[112:115], v[98:99], v[70:71], v[112:115] cbsz:2 abid:2
    v_mfma_f32_4x4x4_16b_bf16 v[116:119], v[98:99], v[72:73], v[116:119] cbsz:2 abid:2
    v_permlane16_swap_b32 v26, v21
    v_mfma_f32_4x4x4_16b_bf16 v[120:123], v[98:99], v[74:75], v[120:123] cbsz:2 abid:2
    v_add_f32 v26, v26, v21
    v_mfma_f32_4x4x4_16b_bf16 v[124:127], v[98:99], v[76:77], v[124:127] cbsz:2 abid:2
    v_mov_b32 v27, v26
    v_mfma_f32_4x4x4_16b_bf16 v[112:115], v[96:97], v[78:79], v[112:115] cbsz:2 abid:3
    v_mfma_f32_4x4x4_16b_bf16 v[116:119], v[96:97], v[80:81], v[116:119] cbsz:2 abid:3
    v_permlane32_swap_b32 v26, v27
    v_mfma_f32_4x4x4_16b_bf16 v[120:123], v[96:97], v[82:83], v[120:123] cbsz:2 abid:3
    v_mul_f32 v26, 0x3b000000, v26
    v_mfma_f32_4x4x4_16b_bf16 v[124:127], v[96:97], v[84:85], v[124:127] cbsz:2 abid:3
    v_mul_f32 v27, 0x3b000000, v27
    v_mfma_f32_4x4x4_16b_bf16 v[112:115], v[98:99], v[86:87], v[112:115] cbsz:2 abid:3
    v_fma_f32 v27, -v26, v26, v27
    v_mfma_f32_4x4x4_16b_bf16 v[116:119], v[98:99], v[88:89], v[116:119] cbsz:2 abid:3
    v_max_f32 v27, 0, v27
    v_mfma_f32_4x4x4_16b_bf16 v[120:123], v[98:99], v[90:91], v[120:123] cbsz:2 abid:3
    v_add_f32 v27, 0x3727c5ac, v27
    v_mfma_f32_4x4x4_16b_bf16 v[124:127], v[98:99], v[92:93], v[124:127] cbsz:2 abid:3
    v_rsq_f32 v27, v27
    v_add_f32 v25, v112, v117
    s_nop 2
    v_add_f32 v20, v122, v127
    v_add_f32 v25, v25, v20
    v_mov_b32 v20, v25
    s_nop 1
    v_permlane16_swap_b32 v25, v20
    v_add_f32 v25, v25, v20
    v_mov_b32 v20, v25
    s_nop 1
    v_permlane32_swap_b32 v25, v20
    v_add_f32 v25, v25, v20
    v_fma_f32 v25, -v26, v24, v25
    v_mul_f32 v25, v25, v27
    s_cmp_lg_u32 s35, 0
    s_cbranch_scc1 L_q1_35
    v_cvt_pk_bf16_f32 v20, v25, v25
    v_add_u32 v21, 0, v15
    v_add_u32 v22, 98304, v15
    v_and_or_b32 v128, v20, s56, v19
    v_and_or_b32 v132, v20, s56, v18
    s_nop 0
    v_mov_b32_dpp v129, v128 quad_perm:[1,1,1,1] row_mask:0xf bank_mask:0xf
    v_mov_b32_dpp v130, v128 quad_perm:[2,2,2,2] row_mask:0xf bank_mask:0xf
    v_mov_b32_dpp v131, v128 quad_perm:[3,3,3,3] row_mask:0xf bank_mask:0xf
    v_mov_b32_dpp v133, v132 quad_perm:[1,1,1,1] row_mask:0xf bank_mask:0xf
    v_mov_b32_dpp v134, v132 quad_perm:[2,2,2,2] row_mask:0xf bank_mask:0xf
    v_mov_b32_dpp v135, v132 quad_perm:[3,3,3,3] row_mask:0xf bank_mask:0xf
    s_mov_b64 exec, 0x1111
    global_store_dwordx4 v21, v[128:131], s[26:27]
    global_store_dwordx4 v22, v[132:135], s[26:27] sc1
    s_mov_b64 exec, -1
    v_add_u32 v23, 0, v14
    s_mov_b32 s44, 256
L_pt_38:
    global_load_dwordx4 v[100:103], v23, s[26:27] sc1
    global_load_dwordx4 v[104:107], v23, s[26:27] offset:16 sc1
    s_waitcnt vmcnt(0)
    v_bitop3_b32 v108, v100, v101, v19 bitop3:0x7e
    v_bitop3_b32 v109, v104, v105, v19 bitop3:0x7e
    v_or_b32 v108, v108, v109
    v_cmp_ne_u16 vcc, 0, v108
    s_cbranch_vccz L_ok_39
    s_sub_u32 s44, s44, 1
    s_cbranch_scc0 L_pt_38
    s_branch L_qgB_36
L_ok_39:
    v_perm_b32 v128, v101, v100, s57
    v_perm_b32 v129, v103, v102, s57
    v_perm_b32 v130, v105, v104, s57
    v_perm_b32 v131, v107, v106, s57
    s_mov_b32 s34, 0
    s_branch L_qm_37
L_qgB_36:
    v_add_u32 v23, 98304, v14
    s_mov_b32 s44, 131072
L_pt_40:
    global_load_dwordx4 v[100:103], v23, s[26:27] sc1
    global_load_dwordx4 v[104:107], v23, s[26:27] offset:16 sc1
    s_waitcnt vmcnt(0)
    v_bitop3_b32 v108, v100, v101, v18 bitop3:0x7e
    v_bitop3_b32 v109, v104, v105, v18 bitop3:0x7e
    v_or_b32 v108, v108, v109
    v_cmp_ne_u16 vcc, 0, v108
    s_cbranch_vccz L_ok_41
    s_sub_u32 s44, s44, 1
    s_cbranch_scc0 L_pt_40
    s_mov_b32 s45, 2
    s_branch L_fail
L_ok_41:
    v_perm_b32 v128, v101, v100, s57
    v_perm_b32 v129, v103, v102, s57
    v_perm_b32 v130, v105, v104, s57
    v_perm_b32 v131, v107, v106, s57
    s_mov_b32 s34, 1
L_qm_37:
    v_mov_b32 v20, s34
    ds_write_b128 v17, v[128:131]
    ds_write_b32 v2, v20 offset:2692
    s_mov_b64 exec, 1
    ds_write_b32 v2, v3 offset:2648
    s_mov_b64 exec, -1
    s_mov_b32 s35, 1
    s_add_u32 s33, s33, 1
    v_mov_b32 v6, s33
    v_and_b32 v7, 0xff, v6
    v_mov_b32 v4, 4
    s_mov_b32 s44, 131072
L_wf_42:
    ds_read_b32 v108, v2 offset:2688
    s_waitcnt lgkmcnt(0)
    v_cmp_eq_u32 vcc, 0, v108
    s_cbranch_vccz L_ok_43
    s_sleep 1
    s_sub_u32 s44, s44, 1
    s_cbranch_scc0 L_wf_42
    s_mov_b32 s45, 53
    s_branch L_fail
L_ok_43:
    s_mov_b32 s44, 131072
    global_load_dwordx4 v[96:99], v13, s[26:27] offset:2048 sc1
    s_sleep 2
L_ps_46:
    global_load_dwordx4 v[100:103], v13, s[26:27] offset:2048 sc1
    s_waitcnt vmcnt(1)
    v_max3_u32 v108, v96, v97, v98
    v_max_u32 v108, v108, v99
    v_cmp_eq_u32 vcc, -1, v108
    s_cbranch_vccz L_pso_48
    global_load_dwordx4 v[96:99], v13, s[26:27] offset:2048 sc1
    s_waitcnt vmcnt(1)
    v_max3_u32 v108, v100, v101, v102
    v_max_u32 v108, v108, v103
    v_cmp_eq_u32 vcc, -1, v108
    s_cbranch_vccz L_pso_49
    s_sub_u32 s44, s44, 1
    s_cbranch_scc0 L_ps_46
    s_mov_b32 s45, 13
    s_branch L_fail
L_pso_48:
    s_branch L_psd_47
L_pso_49:
    v_mov_b32 v96, v100
    v_mov_b32 v97, v101
    v_mov_b32 v98, v102
    v_mov_b32 v99, v103
L_psd_47:
    s_branch L_D0_loop
L_q1_35:
    v_mov_b32_dpp v20, v25 quad_perm:[1,1,3,3] row_mask:0xf bank_mask:0xf
    v_cvt_pk_bf16_f32 v128, v25, v20
    v_min_u32 v128, 0xfffffffe, v128
    s_mov_b64 exec, 0x5555
    s_cmp_lg_u32 s34, 0
    s_cbranch_scc1 L_slow_50
    global_store_dword v16, v128, s[26:27]
L_ret_51:
    s_mov_b64 exec, -1
    s_mov_b32 s44, 131072
    global_load_dwordx4 v[100:103], v13, s[26:27] offset:3072 sc1
    s_sleep 2
L_ps_54:
    global_load_dwordx4 v[104:107], v13, s[26:27] offset:3072 sc1
    s_waitcnt vmcnt(1)
    v_max3_u32 v108, v100, v101, v102
    v_max_u32 v108, v108, v103
    v_cmp_eq_u32 vcc, -1, v108
    s_cbranch_vccz L_pso_56
    global_load_dwordx4 v[100:103], v13, s[26:27] offset:3072 sc1
    s_waitcnt vmcnt(1)
    v_max3_u32 v108, v104, v105, v106
    v_max_u32 v108, v108, v107
    v_cmp_eq_u32 vcc, -1, v108
    s_cbranch_vccz L_pso_57
    s_sub_u32 s44, s44, 1
    s_cbranch_scc0 L_ps_54
    s_mov_b32 s45, 2
    s_branch L_fail
L_pso_56:
    s_branch L_psd_55
L_pso_57:
    v_mov_b32 v100, v104
    v_mov_b32 v101, v105
    v_mov_b32 v102, v106
    v_mov_b32 v103, v107
L_psd_55:
    ds_write_b128 v17, v[100:103]
    s_waitcnt lgkmcnt(0)
    s_barrier
    s_barrier
L_D_end:
    s_endpgm
L_D1:
    s_waitcnt lgkmcnt(0)
    s_load_dword s32, s[26:27], 393216
    v_mov_b32 v2, 0
    v_mov_b32 v3, 1
    v_mov_b32 v4, 0
    v_mov_b32 v5, 0x3f803f80
    v_lshrrev_b32 v8, 4, v1
    v_and_b32 v9, 3, v1
    v_and_b32 v10, 15, v1
    v_lshrrev_b32 v10, 2, v10
    s_mov_b32 s56, 0xffff0000
    s_mov_b32 s57, 0x07060302
    s_mov_b32 s59, 0xffffff00
    v_lshlrev_b32 v12, 12, v8
    v_lshl_add_u32 v12, v10, 5, v12
    v_lshl_add_u32 v12, v9, 3, v12
    s_lshl_b32 s45, s28, 13
    s_add_u32 s45, s45, 458752
    v_lshlrev_b32 v26, 4, v1
    v_add_u32 v13, s45, v26
    s_lshl_b32 s47, s29, 5
    s_add_u32 s46, s45, s47
    v_lshlrev_b32 v14, 3, v8
    v_add_u32 v14, s46, v14
    s_lshl_b32 s45, s28, 11
    s_lshl_b32 s46, s29, 6
    s_add_u32 s46, s46, s45
    s_add_u32 s47, s45, 16384
    v_add_u32 v20, s47, v26
    s_add_u32 s47, s46, 16384
    v_lshlrev_b32 v23, 4, v9
    v_add_u32 v21, s47, v23
    v_add_u32 v19, 2304, v23
    s_lshl_b32 s47, s28, 16
    s_lshl_b32 s48, s29, 11
    s_add_u32 s47, s47, s48
    s_add_u32 s47, s47, 524288
    v_add_u32 v22, s47, v26
    v_lshlrev_b32 v24, 6, v8
    v_add_u32 v24, v24, v23
    v_add_u32 v18, 1280, v24
    s_lshl_b32 s47, s29, 3
    s_add_u32 s47, s47, s28
    s_lshr_b32 s48, s47, 6
    s_lshl_b32 s48, s48, 14
    s_and_b32 s47, s47, 63
    s_lshl_b32 s47, s47, 7
    s_add_u32 s47, s47, s48
    s_add_u32 s47, s47, 131072
    v_lshlrev_b32 v23, 2, v1
    v_add_u32 v15, s47, v23
    v_add_u32 v16, 8192, v15
    v_add_u32 v17, 2368, v23
    v_mov_b32 v128, v5
    v_mov_b32 v129, v5
    v_mov_b32 v130, v5
    v_mov_b32 v131, v5
    s_waitcnt lgkmcnt(0)
    s_add_u32 s33, s32, 1
    v_mov_b32 v6, s33
    v_and_b32 v7, 0xff, v6
    s_mov_b32 s44, 131072
L_wf_58:
    ds_read_b32 v23, v2 offset:2648
    s_waitcnt lgkmcnt(0)
    v_cmp_eq_u32 vcc, 0, v23
    s_cbranch_vccz L_ok_59
    s_sleep 4
    s_sub_u32 s44, s44, 1
    s_cbranch_scc0 L_wf_58
    s_mov_b32 s45, 15
    s_branch L_fail
L_ok_59:
    ds_read_b32 v23, v2 offset:2692
    s_waitcnt lgkmcnt(0)
    v_readfirstlane_b32 s34, v23
    s_mov_b32 s44, 131072
L_wf_60:
    ds_read_b128 v[152:155], v2 offset:2656
    s_waitcnt lgkmcnt(0)
    v_and_b32 v152, v152, v153
    v_and_b32 v154, v154, v155
    v_and_b32 v152, v152, v154
    v_cmp_eq_u32 vcc, 0, v152
    s_cbranch_vccz L_ok_61
    s_sleep 1
    s_sub_u32 s44, s44, 1
    s_cbranch_scc0 L_wf_60
    s_mov_b32 s45, 14
    s_branch L_fail
L_ok_61:
    s_branch L_D1_s3
L_D1_loop:
    s_barrier
    s_barrier
L_D1_s3:
    ds_read_b128 v[132:135], v18 offset:0
    ds_read_b128 v[136:139], v18 offset:256
    ds_read_b128 v[140:143], v18 offset:512
    ds_read_b128 v[144:147], v18 offset:768
    ds_read_b128 v[148:151], v19
    s_waitcnt lgkmcnt(0)
    v_mfma_f32_16x16x32_bf16 v[108:111], v[128:131], v[132:135], 0
    v_max3_f32 v23, v148, v149, v150
    v_max_f32 v124, v23, v151
    v_mfma_f32_16x16x32_bf16 v[112:115], v[128:131], v[136:139], 0
    v_sub_f32 v148, v148, v124
    v_sub_f32 v149, v149, v124
    v_mfma_f32_16x16x32_bf16 v[116:119], v[128:131], v[140:143], 0
    v_exp_f32 v148, v148
    v_sub_f32 v150, v150, v124
    v_mfma_f32_16x16x32_bf16 v[120:123], v[128:131], v[144:147], 0
    v_exp_f32 v149, v149
    v_sub_f32 v151, v151, v124
    v_exp_f32 v150, v150
    v_mul_f32 v125, v148, v108
    v_exp_f32 v151, v151
    v_fmac_f32 v125, v149, v112
    v_fmac_f32 v125, v150, v116
    v_mov_b32 v126, v6
    v_fmac_f32 v125, v151, v120
    v_mov_b32 v127, v6
    s_mov_b64 exec, 15
    s_cmp_lg_u32 s34, 0
    s_cbranch_scc1 L_slow_62
    global_store_dwordx4 v21, v[124:127], s[26:27]
L_ret_63:
    s_mov_b64 exec, -1
    s_cmp_lg_u32 s35, 0
    s_cbranch_scc1 L_wo_64
    s_mov_b32 s44, 131072
L_wf_65:
    ds_read_b32 v23, v2 offset:2636
    s_waitcnt lgkmcnt(0)
    v_cmp_eq_u32 vcc, 0, v23
    s_cbranch_vccz L_ok_66
    s_sleep 1
    s_sub_u32 s44, s44, 1
    s_cbranch_scc0 L_wf_65
    s_mov_b32 s45, 5
    s_branch L_fail
L_ok_66:
    ds_read_b64_tr_b16 v[28:29], v12 offset:20480
    ds_read_b64_tr_b16 v[30:31], v12 offset:20736
    ds_read_b64_tr_b16 v[32:33], v12 offset:20992
    ds_read_b64_tr_b16 v[34:35], v12 offset:21248
    ds_read_b64_tr_b16 v[36:37], v12 offset:20608
    ds_read_b64_tr_b16 v[38:39], v12 offset:20864
    ds_read_b64_tr_b16 v[40:41], v12 offset:21120
    ds_read_b64_tr_b16 v[42:43], v12 offset:21376
    ds_read_b64_tr_b16 v[44:45], v12 offset:21504
    ds_read_b64_tr_b16 v[46:47], v12 offset:21760
    ds_read_b64_tr_b16 v[48:49], v12 offset:22016
    ds_read_b64_tr_b16 v[50:51], v12 offset:22272
    ds_read_b64_tr_b16 v[52:53], v12 offset:21632
    ds_read_b64_tr_b16 v[54:55], v12 offset:21888
    ds_read_b64_tr_b16 v[56:57], v12 offset:22144
    ds_read_b64_tr_b16 v[58:59], v12 offset:22400
    ds_read_b64_tr_b16 v[60:61], v12 offset:22528
    ds_read_b64_tr_b16 v[62:63], v12 offset:22784
    ds_read_b64_tr_b16 v[64:65], v12 offset:23040
    ds_read_b64_tr_b16 v[66:67], v12 offset:23296
    ds_read_b64_tr_b16 v[68:69], v12 offset:22656
    ds_read_b64_tr_b16 v[70:71], v12 offset:22912
    ds_read_b64_tr_b16 v[72:73], v12 offset:23168
    ds_read_b64_tr_b16 v[74:75], v12 offset:23424
    ds_read_b64_tr_b16 v[76:77], v12 offset:23552
    ds_read_b64_tr_b16 v[78:79], v12 offset:23808
    ds_read_b64_tr_b16 v[80:81], v12 offset:24064
    ds_read_b64_tr_b16 v[82:83], v12 offset:24320
    ds_read_b64_tr_b16 v[84:85], v12 offset:23680
    ds_read_b64_tr_b16 v[86:87], v12 offset:23936
    ds_read_b64_tr_b16 v[88:89], v12 offset:24192
    ds_read_b64_tr_b16 v[90:91], v12 offset:24448
    s_waitcnt lgkmcnt(0)
L_wo_64:
    s_mov_b32 s44, 131072
L_ml_67:
    global_load_dwordx4 v[152:155], v20, s[26:27] sc1
    global_load_dwordx4 v[156:159], v20, s[26:27] offset:1024 sc1
    global_load_dwordx4 v[96:99], v22, s[26:27] sc1
    global_load_dwordx4 v[100:103], v22, s[26:27] offset:1024 sc1
    s_waitcnt vmcnt(0)
    v_bitop3_b32 v23, v154, v158, v6 bitop3:0x7e
    v_cmp_ne_u32 vcc, 0, v23
    s_cbranch_vccz L_ok_68
    s_sub_u32 s44, s44, 1
    s_cbranch_scc0 L_ml_67
    s_mov_b32 s45, 3
    s_branch L_fail
L_ok_68:
    v_xor_b32 v96, v96, v7
    v_xor_b32 v97, v97, v7
    v_xor_b32 v98, v98, v7
    v_xor_b32 v99, v99, v7
    v_xor_b32 v100, v100, v7
    v_xor_b32 v101, v101, v7
    v_xor_b32 v102, v102, v7
    v_xor_b32 v103, v103, v7
    v_or3_b32 v23, v96, v97, v98
    v_or3_b32 v24, v99, v100, v101
    v_or3_b32 v23, v23, v102, v103
    v_or_b32 v23, v23, v24
    v_and_b32 v23, 0xff, v23
    v_cmp_ne_u32 vcc, 0, v23
    s_mov_b64 s[60:61], vcc
    s_cbranch_vccz L_opw_69
    global_load_dwordx4 v[96:99], v22, s[26:27] sc1
    global_load_dwordx4 v[100:103], v22, s[26:27] offset:1024 sc1
L_opw_69:
    v_max_f32 v23, v152, v156
    s_nop 1
    v_max_f32_dpp v23, v23, v23 row_ror:4 row_mask:0xf bank_mask:0xf
    s_nop 1
    v_max_f32_dpp v23, v23, v23 row_ror:8 row_mask:0xf bank_mask:0xf
    v_mov_b32 v24, v23
    s_nop 1
    v_permlane16_swap_b32 v23, v24
    v_max_f32 v23, v23, v24
    v_mov_b32 v24, v23
    s_nop 1
    v_permlane32_swap_b32 v23, v24
    v_max_f32 v23, v23, v24
    v_sub_f32 v148, v152, v23
    v_sub_f32 v149, v156, v23
    v_exp_f32 v148, v148
    v_exp_f32 v149, v149
    v_mul_f32 v25, v148, v153
    v_fmac_f32 v25, v149, v157
    s_nop 1
    v_add_f32_dpp v25, v25, v25 row_ror:4 row_mask:0xf bank_mask:0xf
    s_nop 1
    v_add_f32_dpp v25, v25, v25 row_ror:8 row_mask:0xf bank_mask:0xf
    v_mov_b32 v26, v25
    s_nop 1
    v_permlane16_swap_b32 v25, v26
    v_add_f32 v25, v25, v26
    v_mov_b32 v26, v25
    s_nop 1
    v_permlane32_swap_b32 v25, v26
    v_add_f32 v25, v25, v26
    v_rcp_f32 v25, v25
    s_nop 0
    v_mul_f32 v148, v148, v25
    v_mul_f32 v149, v149, v25
    s_cmp_eq_u64 s[60:61], 0
    s_cbranch_scc1 L_opfirst_71
    s_mov_b32 s44, 131072
    s_branch L_psi_75
L_ps_72:
    global_load_dwordx4 v[96:99], v22, s[26:27] sc1
    global_load_dwordx4 v[100:103], v22, s[26:27] offset:1024 sc1
L_psi_75:
    s_waitcnt vmcnt(0)
    v_xor_b32 v96, v96, v7
    v_xor_b32 v97, v97, v7
    v_xor_b32 v98, v98, v7
    v_xor_b32 v99, v99, v7
    v_xor_b32 v100, v100, v7
    v_xor_b32 v101, v101, v7
    v_xor_b32 v102, v102, v7
    v_xor_b32 v103, v103, v7
    v_or3_b32 v23, v96, v97, v98
    v_or3_b32 v24, v99, v100, v101
    v_or3_b32 v23, v23, v102, v103
    v_or_b32 v23, v23, v24
    v_and_b32 v23, 0xff, v23
    v_cmp_ne_u32 vcc, 0, v23
    s_cbranch_vccz L_pso_74
    s_sub_u32 s44, s44, 1
    s_cbranch_scc0 L_ps_72
    s_mov_b32 s45, 4
    s_branch L_fail
L_pso_74:
    v_mul_f32 v108, v148, v96
    v_mul_f32 v109, v148, v97
    v_mul_f32 v110, v148, v98
    v_mul_f32 v111, v148, v99
    v_fmac_f32 v108, v149, v100
    v_fmac_f32 v109, v149, v101
    v_fmac_f32 v110, v149, v102
    v_fmac_f32 v111, v149, v103
    s_branch L_opdone_70
L_opfirst_71:
    v_mul_f32 v108, v148, v96
    v_mul_f32 v109, v148, v97
    v_mul_f32 v110, v148, v98
    v_mul_f32 v111, v148, v99
    v_fmac_f32 v108, v149, v100
    v_fmac_f32 v109, v149, v101
    v_fmac_f32 v110, v149, v102
    v_fmac_f32 v111, v149, v103
L_opdone_70:
    v_add_f32_dpp v108, v108, v108 row_ror:4 row_mask:0xf bank_mask:0xf
    v_add_f32_dpp v109, v109, v109 row_ror:4 row_mask:0xf bank_mask:0xf
    v_add_f32_dpp v110, v110, v110 row_ror:4 row_mask:0xf bank_mask:0xf
    v_add_f32_dpp v111, v111, v111 row_ror:4 row_mask:0xf bank_mask:0xf
    v_add_f32_dpp v108, v108, v108 row_ror:8 row_mask:0xf bank_mask:0xf
    v_add_f32_dpp v109, v109, v109 row_ror:8 row_mask:0xf bank_mask:0xf
    v_add_f32_dpp v110, v110, v110 row_ror:8 row_mask:0xf bank_mask:0xf
    v_add_f32_dpp v111, v111, v111 row_ror:8 row_mask:0xf bank_mask:0xf
    v_permlane16_swap_b32 v108, v109
    v_add_f32 v108, v108, v109
    v_permlane16_swap_b32 v110, v111
    v_add_f32 v110, v110, v111
    s_nop 1
    v_permlane32_swap_b32 v108, v110
    v_add_f32 v108, v108, v110
    s_nop 1
    v_mov_b32_dpp v23, v108 quad_perm:[1,1,3,3] row_mask:0xf bank_mask:0xf
    v_cvt_pk_bf16_f32 v124, v108, v23
    v_min_u32 v124, 0xfffffffe, v124
    s_nop 1
    v_mov_b32_dpp v125, v124 quad_perm:[2,2,2,2] row_mask:0xf bank_mask:0xf
    s_mov_b32 exec_lo, 0x00010001
    s_mov_b32 exec_hi, 0x00010001
    s_cmp_lg_u32 s34, 0
    s_cbranch_scc1 L_slow_76
    global_store_dwordx2 v14, v[124:125], s[26:27]
L_ret_77:
    s_mov_b64 exec, -1
    s_mov_b64 exec, 1
    ds_write_b32 v4, v3 offset:2672
    s_mov_b64 exec, -1
    s_mov_b32 s44, 131072
    global_load_dwordx4 v[92:95], v13, s[26:27] offset:0 sc1
    s_sleep 2
L_ps_80:
    global_load_dwordx4 v[96:99], v13, s[26:27] offset:0 sc1
    s_waitcnt vmcnt(1)
    v_max3_u32 v104, v92, v93, v94
    v_max_u32 v104, v104, v95
    v_cmp_eq_u32 vcc, -1, v104
    s_cbranch_vccz L_pso_82
    global_load_dwordx4 v[92:95], v13, s[26:27] offset:0 sc1
    s_waitcnt vmcnt(1)
    v_max3_u32 v104, v96, v97, v98
    v_max_u32 v104, v104, v99
    v_cmp_eq_u32 vcc, -1, v104
    s_cbranch_vccz L_pso_83
    s_sub_u32 s44, s44, 1
    s_cbranch_scc0 L_ps_80
    s_mov_b32 s45, 7
    s_branch L_fail
L_pso_82:
    s_branch L_psd_81
L_pso_83:
    v_mov_b32 v92, v96
    v_mov_b32 v93, v97
    v_mov_b32 v94, v98
    v_mov_b32 v95, v99
L_psd_81:
    v_mfma_f32_4x4x4_16b_bf16 v[108:111], v[92:93], v[28:29], 0 cbsz:2 abid:0
    v_mfma_f32_4x4x4_16b_bf16 v[112:115], v[92:93], v[30:31], 0 cbsz:2 abid:0
    v_mfma_f32_4x4x4_16b_bf16 v[116:119], v[92:93], v[32:33], 0 cbsz:2 abid:0
    v_mfma_f32_4x4x4_16b_bf16 v[120:123], v[92:93], v[34:35], 0 cbsz:2 abid:0
    v_mfma_f32_4x4x4_16b_bf16 v[108:111], v[94:95], v[36:37], v[108:111] cbsz:2 abid:0
    v_mfma_f32_4x4x4_16b_bf16 v[112:115], v[94:95], v[38:39], v[112:115] cbsz:2 abid:0
    v_mfma_f32_4x4x4_16b_bf16 v[116:119], v[94:95], v[40:41], v[116:119] cbsz:2 abid:0
    v_mfma_f32_4x4x4_16b_bf16 v[120:123], v[94:95], v[42:43], v[120:123] cbsz:2 abid:0
    v_mfma_f32_4x4x4_16b_bf16 v[108:111], v[92:93], v[44:45], v[108:111] cbsz:2 abid:1
    v_mfma_f32_4x4x4_16b_bf16 v[112:115], v[92:93], v[46:47], v[112:115] cbsz:2 abid:1
    v_mfma_f32_4x4x4_16b_bf16 v[116:119], v[92:93], v[48:49], v[116:119] cbsz:2 abid:1
    v_mfma_f32_4x4x4_16b_bf16 v[120:123], v[92:93], v[50:51], v[120:123] cbsz:2 abid:1
    v_mfma_f32_4x4x4_16b_bf16 v[108:111], v[94:95], v[52:53], v[108:111] cbsz:2 abid:1
    v_mfma_f32_4x4x4_16b_bf16 v[112:115], v[94:95], v[54:55], v[112:115] cbsz:2 abid:1
    v_mfma_f32_4x4x4_16b_bf16 v[116:119], v[94:95], v[56:57], v[116:119] cbsz:2 abid:1
    v_mfma_f32_4x4x4_16b_bf16 v[120:123], v[94:95], v[58:59], v[120:123] cbsz:2 abid:1
    v_mfma_f32_4x4x4_16b_bf16 v[108:111], v[92:93], v[60:61], v[108:111] cbsz:2 abid:2
    v_mfma_f32_4x4x4_16b_bf16 v[112:115], v[92:93], v[62:63], v[112:115] cbsz:2 abid:2
    v_mfma_f32_4x4x4_16b_bf16 v[116:119], v[92:93], v[64:65], v[116:119] cbsz:2 abid:2
    v_mfma_f32_4x4x4_16b_bf16 v[120:123], v[92:93], v[66:67], v[120:123] cbsz:2 abid:2
    v_mfma_f32_4x4x4_16b_bf16 v[108:111], v[94:95], v[68:69], v[108:111] cbsz:2 abid:2
    v_mfma_f32_4x4x4_16b_bf16 v[112:115], v[94:95], v[70:71], v[112:115] cbsz:2 abid:2
    v_mfma_f32_4x4x4_16b_bf16 v[116:119], v[94:95], v[72:73], v[116:119] cbsz:2 abid:2
    v_mfma_f32_4x4x4_16b_bf16 v[120:123], v[94:95], v[74:75], v[120:123] cbsz:2 abid:2
    v_mfma_f32_4x4x4_16b_bf16 v[108:111], v[92:93], v[76:77], v[108:111] cbsz:2 abid:3
    v_mfma_f32_4x4x4_16b_bf16 v[112:115], v[92:93], v[78:79], v[112:115] cbsz:2 abid:3
    v_mfma_f32_4x4x4_16b_bf16 v[116:119], v[92:93], v[80:81], v[116:119] cbsz:2 abid:3
    v_mfma_f32_4x4x4_16b_bf16 v[120:123], v[92:93], v[82:83], v[120:123] cbsz:2 abid:3
    v_mfma_f32_4x4x4_16b_bf16 v[108:111], v[94:95], v[84:85], v[108:111] cbsz:2 abid:3
    v_mfma_f32_4x4x4_16b_bf16 v[112:115], v[94:95], v[86:87], v[112:115] cbsz:2 abid:3
    v_mfma_f32_4x4x4_16b_bf16 v[116:119], v[94:95], v[88:89], v[116:119] cbsz:2 abid:3
    v_mfma_f32_4x4x4_16b_bf16 v[120:123], v[94:95], v[90:91], v[120:123] cbsz:2 abid:3
    s_nop 2
    v_add_f32 v27, v108, v113
    s_nop 0
    v_add_f32 v23, v118, v123
    v_add_f32 v27, v27, v23
    v_mov_b32 v23, v27
    s_nop 1
    v_permlane16_swap_b32 v27, v23
    v_add_f32 v27, v27, v23
    v_mov_b32 v23, v27
    s_nop 1
    v_permlane32_swap_b32 v27, v23
    v_add_f32 v27, v27, v23
    v_and_or_b32 v124, v27, s59, v7
    s_nop 1
    v_mov_b32_dpp v125, v124 quad_perm:[1,1,1,1] row_mask:0xf bank_mask:0xf
    v_mov_b32_dpp v126, v124 quad_perm:[2,2,2,2] row_mask:0xf bank_mask:0xf
    v_mov_b32_dpp v127, v124 quad_perm:[3,3,3,3] row_mask:0xf bank_mask:0xf
    s_mov_b64 exec, 0x1111
    global_store_dwordx4 v15, v[124:127], s[26:27] sc1
    global_store_dwordx4 v16, v[124:127], s[26:27] sc1
    ds_write_b128 v17, v[124:127] offset:0
    s_mov_b64 exec, 1
    ds_write_b32 v4, v3 offset:2696
    s_mov_b64 exec, -1
    s_cmp_lg_u32 s35, 0
    s_cbranch_scc1 L_D_end
    s_mov_b32 s35, 1
    s_add_u32 s33, s33, 1
    v_mov_b32 v6, s33
    v_and_b32 v7, 0xff, v6
    v_mov_b32 v4, 4
    v_add_u32 v15, 0x20000, v15
    v_add_u32 v16, 0x20000, v16
    v_add_u32 v17, 128, v17
    v_add_u32 v13, 1024, v13
    v_add_u32 v14, 1024, v14
    s_waitcnt vmcnt(0)
    s_branch L_D1_loop
L_D2:
    s_waitcnt lgkmcnt(0)
    s_load_dword s32, s[26:27], 393216
    v_mov_b32 v2, 0
    v_mov_b32 v3, 1
    v_mov_b32 v4, 0
    v_mov_b32 v5, 0x3f803f80
    v_lshrrev_b32 v8, 4, v1
    v_and_b32 v9, 3, v1
    v_and_b32 v10, 15, v1
    v_lshrrev_b32 v10, 2, v10
    s_mov_b32 s56, 0xffff0000
    s_mov_b32 s57, 0x07060302
    s_mov_b32 s59, 0xffffff00
    v_lshlrev_b32 v12, 12, v8
    v_lshl_add_u32 v12, v10, 5, v12
    v_lshl_add_u32 v12, v9, 3, v12
    s_lshl_b32 s45, s28, 13
    s_add_u32 s45, s45, 458752
    v_lshlrev_b32 v15, 4, v1
    v_add_u32 v13, s45, v15
    s_lshr_b32 s47, s29, 1
    s_lshl_b32 s47, s47, 5
    s_and_b32 s48, s29, 1
    s_lshl_b32 s48, s48, 9
    s_add_u32 s47, s47, s48
    s_add_u32 s46, s45, s47
    s_add_u32 s46, s46, 4096
    v_lshlrev_b32 v14, 1, v1
    v_add_u32 v14, s46, v14
    v_mov_b32 v22, v5
    v_mov_b32 v23, v5
    s_waitcnt lgkmcnt(0)
    s_add_u32 s33, s32, 1
    v_mov_b32 v6, s33
    v_and_b32 v7, 0xff, v6
    s_mov_b32 s44, 131072
L_wf_84:
    ds_read_b32 v15, v2 offset:2648
    s_waitcnt lgkmcnt(0)
    v_cmp_eq_u32 vcc, 0, v15
    s_cbranch_vccz L_ok_85
    s_sleep 4
    s_sub_u32 s44, s44, 1
    s_cbranch_scc0 L_wf_84
    s_mov_b32 s45, 15
    s_branch L_fail
L_ok_85:
    ds_read_b32 v15, v2 offset:2692
    s_waitcnt lgkmcnt(0)
    v_readfirstlane_b32 s34, v15
    s_cmp_ge_u32 s29, 28
    s_cbranch_scc1 L_D2_s6
    s_mov_b32 s44, 131072
L_wf_87:
    ds_read_b32 v15, v2 offset:2640
    s_waitcnt lgkmcnt(0)
    v_cmp_eq_u32 vcc, 0, v15
    s_cbranch_vccz L_ok_88
    s_sleep 1
    s_sub_u32 s44, s44, 1
    s_cbranch_scc0 L_wf_87
    s_mov_b32 s45, 8
    s_branch L_fail
L_ok_88:
    ds_read_b64_tr_b16 v[24:25], v12 offset:36864
    ds_read_b64_tr_b16 v[26:27], v12 offset:37120
    ds_read_b64_tr_b16 v[28:29], v12 offset:37376
    ds_read_b64_tr_b16 v[30:31], v12 offset:37632
    ds_read_b64_tr_b16 v[32:33], v12 offset:36992
    ds_read_b64_tr_b16 v[34:35], v12 offset:37248
    ds_read_b64_tr_b16 v[36:37], v12 offset:37504
    ds_read_b64_tr_b16 v[38:39], v12 offset:37760
    ds_read_b64_tr_b16 v[40:41], v12 offset:37888
    ds_read_b64_tr_b16 v[42:43], v12 offset:38144
    ds_read_b64_tr_b16 v[44:45], v12 offset:38400
    ds_read_b64_tr_b16 v[46:47], v12 offset:38656
    ds_read_b64_tr_b16 v[48:49], v12 offset:38016
    ds_read_b64_tr_b16 v[50:51], v12 offset:38272
    ds_read_b64_tr_b16 v[52:53], v12 offset:38528
    ds_read_b64_tr_b16 v[54:55], v12 offset:38784
    ds_read_b64_tr_b16 v[56:57], v12 offset:38912
    ds_read_b64_tr_b16 v[58:59], v12 offset:39168
    ds_read_b64_tr_b16 v[60:61], v12 offset:39424
    ds_read_b64_tr_b16 v[62:63], v12 offset:39680
    ds_read_b64_tr_b16 v[64:65], v12 offset:39040
    ds_read_b64_tr_b16 v[66:67], v12 offset:39296
    ds_read_b64_tr_b16 v[68:69], v12 offset:39552
    ds_read_b64_tr_b16 v[70:71], v12 offset:39808
    ds_read_b64_tr_b16 v[72:73], v12 offset:39936
    ds_read_b64_tr_b16 v[74:75], v12 offset:40192
    ds_read_b64_tr_b16 v[76:77], v12 offset:40448
    ds_read_b64_tr_b16 v[78:79], v12 offset:40704
    ds_read_b64_tr_b16 v[80:81], v12 offset:40064
    ds_read_b64_tr_b16 v[82:83], v12 offset:40320
    ds_read_b64_tr_b16 v[84:85], v12 offset:40576
    ds_read_b64_tr_b16 v[86:87], v12 offset:40832
    s_waitcnt lgkmcnt(0)
    v_mfma_f32_4x4x4_16b_bf16 v[104:107], v[22:23], v[24:25], 0 cbsz:2 abid:0
    v_mfma_f32_4x4x4_16b_bf16 v[108:111], v[22:23], v[26:27], 0 cbsz:2 abid:0
    v_mfma_f32_4x4x4_16b_bf16 v[112:115], v[22:23], v[28:29], 0 cbsz:2 abid:0
    v_mfma_f32_4x4x4_16b_bf16 v[116:119], v[22:23], v[30:31], 0 cbsz:2 abid:0
    v_mfma_f32_4x4x4_16b_bf16 v[104:107], v[22:23], v[32:33], v[104:107] cbsz:2 abid:0
    v_mfma_f32_4x4x4_16b_bf16 v[108:111], v[22:23], v[34:35], v[108:111] cbsz:2 abid:0
    v_mfma_f32_4x4x4_16b_bf16 v[112:115], v[22:23], v[36:37], v[112:115] cbsz:2 abid:0
    v_mfma_f32_4x4x4_16b_bf16 v[116:119], v[22:23], v[38:39], v[116:119] cbsz:2 abid:0
    v_mfma_f32_4x4x4_16b_bf16 v[104:107], v[22:23], v[40:41], v[104:107] cbsz:2 abid:1
    v_mfma_f32_4x4x4_16b_bf16 v[108:111], v[22:23], v[42:43], v[108:111] cbsz:2 abid:1
    v_mfma_f32_4x4x4_16b_bf16 v[112:115], v[22:23], v[44:45], v[112:115] cbsz:2 abid:1
    v_mfma_f32_4x4x4_16b_bf16 v[116:119], v[22:23], v[46:47], v[116:119] cbsz:2 abid:1
    v_mfma_f32_4x4x4_16b_bf16 v[104:107], v[22:23], v[48:49], v[104:107] cbsz:2 abid:1
    v_mfma_f32_4x4x4_16b_bf16 v[108:111], v[22:23], v[50:51], v[108:111] cbsz:2 abid:1
    v_mfma_f32_4x4x4_16b_bf16 v[112:115], v[22:23], v[52:53], v[112:115] cbsz:2 abid:1
    v_mfma_f32_4x4x4_16b_bf16 v[116:119], v[22:23], v[54:55], v[116:119] cbsz:2 abid:1
    v_mfma_f32_4x4x4_16b_bf16 v[104:107], v[22:23], v[56:57], v[104:107] cbsz:2 abid:2
    v_mfma_f32_4x4x4_16b_bf16 v[108:111], v[22:23], v[58:59], v[108:111] cbsz:2 abid:2
    v_mfma_f32_4x4x4_16b_bf16 v[112:115], v[22:23], v[60:61], v[112:115] cbsz:2 abid:2
    v_mfma_f32_4x4x4_16b_bf16 v[116:119], v[22:23], v[62:63], v[116:119] cbsz:2 abid:2
    v_mfma_f32_4x4x4_16b_bf16 v[104:107], v[22:23], v[64:65], v[104:107] cbsz:2 abid:2
    v_mfma_f32_4x4x4_16b_bf16 v[108:111], v[22:23], v[66:67], v[108:111] cbsz:2 abid:2
    v_mfma_f32_4x4x4_16b_bf16 v[112:115], v[22:23], v[68:69], v[112:115] cbsz:2 abid:2
    v_mfma_f32_4x4x4_16b_bf16 v[116:119], v[22:23], v[70:71], v[116:119] cbsz:2 abid:2
    v_mfma_f32_4x4x4_16b_bf16 v[104:107], v[22:23], v[72:73], v[104:107] cbsz:2 abid:3
    v_mfma_f32_4x4x4_16b_bf16 v[108:111], v[22:23], v[74:75], v[108:111] cbsz:2 abid:3
    v_mfma_f32_4x4x4_16b_bf16 v[112:115], v[22:23], v[76:77], v[112:115] cbsz:2 abid:3
    v_mfma_f32_4x4x4_16b_bf16 v[116:119], v[22:23], v[78:79], v[116:119] cbsz:2 abid:3
    v_mfma_f32_4x4x4_16b_bf16 v[104:107], v[22:23], v[80:81], v[104:107] cbsz:2 abid:3
    v_mfma_f32_4x4x4_16b_bf16 v[108:111], v[22:23], v[82:83], v[108:111] cbsz:2 abid:3
    v_mfma_f32_4x4x4_16b_bf16 v[112:115], v[22:23], v[84:85], v[112:115] cbsz:2 abid:3
    v_mfma_f32_4x4x4_16b_bf16 v[116:119], v[22:23], v[86:87], v[116:119] cbsz:2 abid:3
    s_nop 2
    v_add_f32 v18, v104, v108
    s_nop 0
    v_add_f32 v15, v112, v116
    v_add_f32 v18, v18, v15
    v_mov_b32 v15, v18
    s_nop 1
    v_permlane16_swap_b32 v18, v15
    v_add_f32 v18, v18, v15
    v_mov_b32 v15, v18
    s_nop 1
    v_permlane32_swap_b32 v18, v15
    v_add_f32 v18, v18, v15
    s_branch L_D2_s6
L_D2_loop:
    s_barrier
    s_barrier
L_D2_s6:
    s_mov_b32 s44, 131072
L_wf_89:
    ds_read_b32 v100, v4 offset:2680
    s_waitcnt lgkmcnt(0)
    v_cmp_eq_u32 vcc, 0, v100
    s_cbranch_vccz L_ok_90
    s_sleep 1
    s_sub_u32 s44, s44, 1
    s_cbranch_scc0 L_wf_89
    s_mov_b32 s45, 50
    s_branch L_fail
L_ok_90:
    s_cmp_ge_u32 s29, 28
    s_cbranch_scc1 L_noffn_86
    s_mov_b32 s44, 131072
    global_load_dwordx4 v[88:91], v13, s[26:27] offset:2048 sc1
    s_sleep 2
L_ps_93:
    global_load_dwordx4 v[92:95], v13, s[26:27] offset:2048 sc1
    s_waitcnt vmcnt(1)
    v_max3_u32 v100, v88, v89, v90
    v_max_u32 v100, v100, v91
    v_cmp_eq_u32 vcc, -1, v100
    s_cbranch_vccz L_pso_95
    global_load_dwordx4 v[88:91], v13, s[26:27] offset:2048 sc1
    s_waitcnt vmcnt(1)
    v_max3_u32 v100, v92, v93, v94
    v_max_u32 v100, v100, v95
    v_cmp_eq_u32 vcc, -1, v100
    s_cbranch_vccz L_pso_96
    s_sub_u32 s44, s44, 1
    s_cbranch_scc0 L_ps_93
    s_mov_b32 s45, 10
    s_branch L_fail
L_pso_95:
    s_branch L_psd_94
L_pso_96:
    v_mov_b32 v88, v92
    v_mov_b32 v89, v93
    v_mov_b32 v90, v94
    v_mov_b32 v91, v95
L_psd_94:
    v_mfma_f32_4x4x4_16b_bf16 v[104:107], v[88:89], v[24:25], 0 cbsz:2 abid:0
    v_dot2_f32_bf16 v20, v88, v5, 0
    v_mfma_f32_4x4x4_16b_bf16 v[108:111], v[88:89], v[26:27], 0 cbsz:2 abid:0
    v_dot2_f32_bf16 v21, v88, v88, 0
    v_mfma_f32_4x4x4_16b_bf16 v[112:115], v[88:89], v[28:29], 0 cbsz:2 abid:0
    v_dot2_f32_bf16 v20, v89, v5, v20
    v_mfma_f32_4x4x4_16b_bf16 v[116:119], v[88:89], v[30:31], 0 cbsz:2 abid:0
    v_dot2_f32_bf16 v21, v89, v89, v21
    v_mfma_f32_4x4x4_16b_bf16 v[104:107], v[90:91], v[32:33], v[104:107] cbsz:2 abid:0
    v_dot2_f32_bf16 v20, v90, v5, v20
    v_mfma_f32_4x4x4_16b_bf16 v[108:111], v[90:91], v[34:35], v[108:111] cbsz:2 abid:0
    v_dot2_f32_bf16 v21, v90, v90, v21
    v_mfma_f32_4x4x4_16b_bf16 v[112:115], v[90:91], v[36:37], v[112:115] cbsz:2 abid:0
    v_dot2_f32_bf16 v20, v91, v5, v20
    v_mfma_f32_4x4x4_16b_bf16 v[116:119], v[90:91], v[38:39], v[116:119] cbsz:2 abid:0
    v_dot2_f32_bf16 v21, v91, v91, v21
    v_mfma_f32_4x4x4_16b_bf16 v[104:107], v[88:89], v[40:41], v[104:107] cbsz:2 abid:1
    v_mfma_f32_4x4x4_16b_bf16 v[108:111], v[88:89], v[42:43], v[108:111] cbsz:2 abid:1
    s_nop 0
    v_permlane32_swap_b32 v20, v21
    v_mfma_f32_4x4x4_16b_bf16 v[112:115], v[88:89], v[44:45], v[112:115] cbsz:2 abid:1
    v_add_f32 v20, v20, v21
    v_mfma_f32_4x4x4_16b_bf16 v[116:119], v[88:89], v[46:47], v[116:119] cbsz:2 abid:1
    v_mfma_f32_4x4x4_16b_bf16 v[104:107], v[90:91], v[48:49], v[104:107] cbsz:2 abid:1
    v_add_f32_dpp v20, v20, v20 row_ror:1 row_mask:0xf bank_mask:0xf
    v_mfma_f32_4x4x4_16b_bf16 v[108:111], v[90:91], v[50:51], v[108:111] cbsz:2 abid:1
    v_mfma_f32_4x4x4_16b_bf16 v[112:115], v[90:91], v[52:53], v[112:115] cbsz:2 abid:1
    v_add_f32_dpp v20, v20, v20 row_ror:2 row_mask:0xf bank_mask:0xf
    v_mfma_f32_4x4x4_16b_bf16 v[116:119], v[90:91], v[54:55], v[116:119] cbsz:2 abid:1
    v_mfma_f32_4x4x4_16b_bf16 v[104:107], v[88:89], v[56:57], v[104:107] cbsz:2 abid:2
    v_add_f32_dpp v20, v20, v20 row_ror:4 row_mask:0xf bank_mask:0xf
    v_mfma_f32_4x4x4_16b_bf16 v[108:111], v[88:89], v[58:59], v[108:111] cbsz:2 abid:2
    v_mfma_f32_4x4x4_16b_bf16 v[112:115], v[88:89], v[60:61], v[112:115] cbsz:2 abid:2
    v_add_f32_dpp v20, v20, v20 row_ror:8 row_mask:0xf bank_mask:0xf
    v_mfma_f32_4x4x4_16b_bf16 v[116:119], v[88:89], v[62:63], v[116:119] cbsz:2 abid:2
    v_mov_b32 v16, v20
    v_mfma_f32_4x4x4_16b_bf16 v[104:107], v[90:91], v[64:65], v[104:107] cbsz:2 abid:2
    v_mfma_f32_4x4x4_16b_bf16 v[108:111], v[90:91], v[66:67], v[108:111] cbsz:2 abid:2
    v_permlane16_swap_b32 v20, v16
    v_mfma_f32_4x4x4_16b_bf16 v[112:115], v[90:91], v[68:69], v[112:115] cbsz:2 abid:2
    v_add_f32 v20, v20, v16
    v_mfma_f32_4x4x4_16b_bf16 v[116:119], v[90:91], v[70:71], v[116:119] cbsz:2 abid:2
    v_mov_b32 v21, v20
    v_mfma_f32_4x4x4_16b_bf16 v[104:107], v[88:89], v[72:73], v[104:107] cbsz:2 abid:3
    v_mfma_f32_4x4x4_16b_bf16 v[108:111], v[88:89], v[74:75], v[108:111] cbsz:2 abid:3
    v_permlane32_swap_b32 v20, v21
    v_mfma_f32_4x4x4_16b_bf16 v[112:115], v[88:89], v[76:77], v[112:115] cbsz:2 abid:3
    v_mul_f32 v20, 0x3b000000, v20
    v_mfma_f32_4x4x4_16b_bf16 v[116:119], v[88:89], v[78:79], v[116:119] cbsz:2 abid:3
    v_mul_f32 v21, 0x3b000000, v21
    v_mfma_f32_4x4x4_16b_bf16 v[104:107], v[90:91], v[80:81], v[104:107] cbsz:2 abid:3
    v_fma_f32 v21, -v20, v20, v21
    v_mfma_f32_4x4x4_16b_bf16 v[108:111], v[90:91], v[82:83], v[108:111] cbsz:2 abid:3
    v_max_f32 v21, 0, v21
    v_mfma_f32_4x4x4_16b_bf16 v[112:115], v[90:91], v[84:85], v[112:115] cbsz:2 abid:3
    v_add_f32 v21, 0x3727c5ac, v21
    v_mfma_f32_4x4x4_16b_bf16 v[116:119], v[90:91], v[86:87], v[116:119] cbsz:2 abid:3
    v_rsq_f32 v21, v21
    v_add_f32 v19, v104, v109
    s_nop 2
    v_add_f32 v15, v114, v119
    v_add_f32 v19, v19, v15
    v_mov_b32 v15, v19
    s_nop 1
    v_permlane16_swap_b32 v19, v15
    v_add_f32 v19, v19, v15
    v_mov_b32 v15, v19
    s_nop 1
    v_permlane32_swap_b32 v19, v15
    v_add_f32 v19, v19, v15
    v_fma_f32 v19, -v20, v18, v19
    v_mul_f32 v19, v19, v21
    s_nop 1
    v_mov_b32_dpp v15, v19 quad_perm:[1,1,3,3] row_mask:0xf bank_mask:0xf
    v_cvt_pk_bf16_f32 v120, v19, v15
    v_min_u32 v120, 0xfffffffe, v120
    s_mov_b64 exec, 0x5555
    s_cmp_lg_u32 s34, 0
    s_cbranch_scc1 L_slow_97
    global_store_dword v14, v120, s[26:27]
L_ret_98:
    s_mov_b64 exec, -1
L_noffn_86:
    s_mov_b64 exec, 1
    ds_write_b32 v4, v3 offset:2712
    s_mov_b64 exec, -1
    s_cmp_lg_u32 s35, 0
    s_cbranch_scc1 L_D_end
    s_mov_b32 s35, 1
    s_add_u32 s33, s33, 1
    v_mov_b32 v6, s33
    v_and_b32 v7, 0xff, v6
    v_mov_b32 v4, 4
    v_add_u32 v13, 1024, v13
    v_add_u32 v14, 1024, v14
    s_branch L_D2_loop
L_D3:
    s_waitcnt lgkmcnt(0)
    s_load_dword s32, s[26:27], 393216
    v_mov_b32 v2, 0
    v_mov_b32 v3, 1
    v_mov_b32 v4, 0
    v_mov_b32 v5, 0x3f803f80
    v_lshrrev_b32 v8, 4, v1
    v_and_b32 v9, 3, v1
    v_and_b32 v10, 15, v1
    v_lshrrev_b32 v10, 2, v10
    s_mov_b32 s56, 0xffff0000
    s_mov_b32 s57, 0x07060302
    s_mov_b32 s59, 0xffffff00
    s_getpc_b64 s[60:61]
L_pc:
    s_sub_u32 s60, s60, L_pc-interleave_layers__sliding_block_cached__glu_gated_swiglu__decode_kernel
    s_subb_u32 s61, s61, 0
    s_and_b32 s45, s29, 1
    s_lshl_b32 s45, s45, 13
    v_lshlrev_b32 v17, 6, v1
    v_add_u32 v17, s45, v17
    v_add_u32 v18, 4096, v17
    s_mov_b32 s45, L_end-interleave_layers__sliding_block_cached__glu_gated_swiglu__decode_kernel
    v_min_u32 v17, s45, v17
    v_min_u32 v18, s45, v18
    global_load_dword v11, v17, s[60:61]
    global_load_dword v11, v18, s[60:61]
    v_lshlrev_b32 v12, 11, v8
    v_lshl_add_u32 v12, v10, 5, v12
    v_lshl_add_u32 v12, v9, 3, v12
    s_lshl_b32 s45, s28, 13
    s_add_u32 s45, s45, 462848
    v_lshlrev_b32 v13, 3, v1
    v_add_u32 v13, s45, v13
    s_lshl_b32 s47, s29, 3
    s_add_u32 s47, s47, s28
    s_lshr_b32 s48, s47, 6
    s_lshl_b32 s48, s48, 14
    s_and_b32 s47, s47, 63
    s_lshl_b32 s47, s47, 7
    s_add_u32 s47, s47, s48
    s_add_u32 s47, s47, 196608
    v_lshlrev_b32 v17, 2, v1
    v_add_u32 v14, s47, v17
    v_add_u32 v15, 8192, v14
    v_add_u32 v16, 2368, v17
    v_mov_b32 v100, 0xbfb8aa3b
    v_mov_b32 v101, 0xbfb8aa3b
    v_mov_b32 v102, 1.0
    v_mov_b32 v103, 1.0
    s_waitcnt lgkmcnt(0)
    s_add_u32 s33, s32, 1
    v_mov_b32 v6, s33
    v_and_b32 v7, 0xff, v6
    s_mov_b32 s44, 131072
L_wf_99:
    ds_read_b32 v17, v2 offset:2624
    s_waitcnt lgkmcnt(0)
    v_cmp_eq_u32 vcc, 0, v17
    s_cbranch_vccz L_ok_100
    s_sleep 4
    s_sub_u32 s44, s44, 1
    s_cbranch_scc0 L_wf_99
    s_mov_b32 s45, 16
    s_branch L_fail
L_ok_100:
    s_lshl_b32 s47, s28, 16
    s_lshl_b32 s48, s29, 11
    s_add_u32 s47, s47, s48
    s_add_u32 s47, s47, 524288
    v_lshlrev_b32 v17, 7, v1
    v_add_u32 v17, s47, v17
    s_mov_b64 exec, 0xffff
    global_load_dword v11, v17, s[26:27] sc1
    s_mov_b64 exec, -1
    v_and_b32 v17, 7, v1
    s_lshl_b32 s47, s29, 3
    v_add_u32 v17, s47, v17
    v_lshrrev_b32 v18, 6, v17
    v_lshlrev_b32 v18, 14, v18
    v_and_b32 v17, 63, v17
    v_lshl_add_u32 v17, v17, 7, v18
    v_lshrrev_b32 v18, 3, v1
    v_and_b32 v18, 1, v18
    v_lshl_add_u32 v17, v18, 13, v17
    v_lshrrev_b32 v18, 4, v1
    v_lshl_add_u32 v17, v18, 16, v17
    v_add_u32 v17, 131072, v17
    global_load_dword v11, v17, s[26:27] sc1
    s_mov_b32 s44, 131072
L_wf_101:
    ds_read_b32 v17, v2 offset:2644
    s_waitcnt lgkmcnt(0)
    v_cmp_eq_u32 vcc, 0, v17
    s_cbranch_vccz L_ok_102
    s_sleep 2
    s_sub_u32 s44, s44, 1
    s_cbranch_scc0 L_wf_101
    s_mov_b32 s45, 9
    s_branch L_fail
L_ok_102:
    ds_read_b64_tr_b16 v[20:21], v12 offset:53248
    ds_read_b64_tr_b16 v[22:23], v12 offset:53376
    ds_read_b64_tr_b16 v[24:25], v12 offset:53504
    ds_read_b64_tr_b16 v[26:27], v12 offset:53632
    ds_read_b64_tr_b16 v[28:29], v12 offset:53760
    ds_read_b64_tr_b16 v[30:31], v12 offset:53888
    ds_read_b64_tr_b16 v[32:33], v12 offset:54016
    ds_read_b64_tr_b16 v[34:35], v12 offset:54144
    ds_read_b64_tr_b16 v[36:37], v12 offset:54272
    ds_read_b64_tr_b16 v[38:39], v12 offset:54400
    ds_read_b64_tr_b16 v[40:41], v12 offset:54528
    ds_read_b64_tr_b16 v[42:43], v12 offset:54656
    ds_read_b64_tr_b16 v[44:45], v12 offset:54784
    ds_read_b64_tr_b16 v[46:47], v12 offset:54912
    ds_read_b64_tr_b16 v[48:49], v12 offset:55040
    ds_read_b64_tr_b16 v[50:51], v12 offset:55168
    s_waitcnt lgkmcnt(0)
    s_branch L_D3_s7
L_D3_loop:
    s_barrier
    s_barrier
L_D3_s7:
    v_mov_b32 v52, 0
    v_mov_b32 v53, 0
    s_mov_b32 s44, 131072
L_wf_103:
    ds_read_b32 v64, v4 offset:2712
    s_waitcnt lgkmcnt(0)
    v_cmp_eq_u32 vcc, 0, v64
    s_cbranch_vccz L_ok_104
    s_sleep 1
    s_sub_u32 s44, s44, 1
    s_cbranch_scc0 L_wf_103
    s_mov_b32 s45, 51
    s_branch L_fail
L_ok_104:
    s_mov_b32 exec_hi, 0x00ffffff
    s_mov_b32 s44, 131072
L_ps_105:
    global_load_dwordx2 v[56:57], v13, s[26:27] sc1
    global_load_dwordx2 v[58:59], v13, s[26:27] offset:512 sc1
L_psi_108:
    s_waitcnt vmcnt(0)
    v_max3_u32 v64, v56, v57, v58
    v_max_u32 v64, v64, v59
    v_cmp_eq_u32 vcc, -1, v64
    s_cbranch_vccz L_pso_107
    s_sub_u32 s44, s44, 1
    s_cbranch_scc0 L_ps_105
    s_mov_b32 s45, 11
    s_branch L_fail
L_pso_107:
    v_lshlrev_b32 v88, 16, v56
    v_and_b32 v89, s56, v56
    v_lshlrev_b32 v90, 16, v57
    v_and_b32 v91, s56, v57
    v_lshlrev_b32 v92, 16, v58
    v_and_b32 v93, s56, v58
    v_lshlrev_b32 v94, 16, v59
    v_and_b32 v95, s56, v59
    v_pk_mul_f32 v[96:97], v[88:89], v[100:101]
    v_pk_mul_f32 v[98:99], v[90:91], v[100:101]
    v_exp_f32 v96, v96
    v_exp_f32 v97, v97
    v_exp_f32 v98, v98
    v_exp_f32 v99, v99
    v_pk_add_f32 v[96:97], v[96:97], v[102:103]
    v_pk_add_f32 v[98:99], v[98:99], v[102:103]
    v_rcp_f32 v96, v96
    v_rcp_f32 v97, v97
    v_rcp_f32 v98, v98
    v_rcp_f32 v99, v99
    v_pk_mul_f32 v[96:97], v[96:97], v[88:89]
    v_pk_mul_f32 v[98:99], v[98:99], v[90:91]
    v_cvt_pk_bf16_f32 v88, v96, v97
    v_cvt_pk_bf16_f32 v90, v98, v99
    v_lshlrev_b32 v96, 16, v88
    v_and_b32 v97, s56, v88
    v_lshlrev_b32 v98, 16, v90
    v_and_b32 v99, s56, v90
    v_pk_mul_f32 v[96:97], v[96:97], v[92:93]
    v_pk_mul_f32 v[98:99], v[98:99], v[94:95]
    v_cvt_pk_bf16_f32 v52, v96, v97
    v_cvt_pk_bf16_f32 v53, v98, v99
    s_mov_b64 exec, -1
    s_nop 0
    v_mfma_f32_4x4x4_16b_bf16 v[68:71], v[52:53], v[20:21], 0 cbsz:2 abid:0
    v_mfma_f32_4x4x4_16b_bf16 v[72:75], v[52:53], v[22:23], 0 cbsz:2 abid:0
    v_mfma_f32_4x4x4_16b_bf16 v[76:79], v[52:53], v[24:25], 0 cbsz:2 abid:0
    v_mfma_f32_4x4x4_16b_bf16 v[80:83], v[52:53], v[26:27], 0 cbsz:2 abid:0
    v_mfma_f32_4x4x4_16b_bf16 v[68:71], v[52:53], v[28:29], v[68:71] cbsz:2 abid:1
    v_mfma_f32_4x4x4_16b_bf16 v[72:75], v[52:53], v[30:31], v[72:75] cbsz:2 abid:1
    v_mfma_f32_4x4x4_16b_bf16 v[76:79], v[52:53], v[32:33], v[76:79] cbsz:2 abid:1
    v_mfma_f32_4x4x4_16b_bf16 v[80:83], v[52:53], v[34:35], v[80:83] cbsz:2 abid:1
    v_mfma_f32_4x4x4_16b_bf16 v[68:71], v[52:53], v[36:37], v[68:71] cbsz:2 abid:2
    v_mfma_f32_4x4x4_16b_bf16 v[72:75], v[52:53], v[38:39], v[72:75] cbsz:2 abid:2
    v_mfma_f32_4x4x4_16b_bf16 v[76:79], v[52:53], v[40:41], v[76:79] cbsz:2 abid:2
    v_mfma_f32_4x4x4_16b_bf16 v[80:83], v[52:53], v[42:43], v[80:83] cbsz:2 abid:2
    v_mfma_f32_4x4x4_16b_bf16 v[68:71], v[52:53], v[44:45], v[68:71] cbsz:2 abid:3
    v_mfma_f32_4x4x4_16b_bf16 v[72:75], v[52:53], v[46:47], v[72:75] cbsz:2 abid:3
    v_mfma_f32_4x4x4_16b_bf16 v[76:79], v[52:53], v[48:49], v[76:79] cbsz:2 abid:3
    v_mfma_f32_4x4x4_16b_bf16 v[80:83], v[52:53], v[50:51], v[80:83] cbsz:2 abid:3
    s_nop 2
    v_add_f32 v19, v68, v73
    s_nop 0
    v_add_f32 v17, v78, v83
    v_add_f32 v19, v19, v17
    v_mov_b32 v17, v19
    s_nop 1
    v_permlane16_swap_b32 v19, v17
    v_add_f32 v19, v19, v17
    v_mov_b32 v17, v19
    s_nop 1
    v_permlane32_swap_b32 v19, v17
    v_add_f32 v19, v19, v17
    v_and_or_b32 v84, v19, s59, v7
    s_nop 1
    v_mov_b32_dpp v85, v84 quad_perm:[1,1,1,1] row_mask:0xf bank_mask:0xf
    v_mov_b32_dpp v86, v84 quad_perm:[2,2,2,2] row_mask:0xf bank_mask:0xf
    v_mov_b32_dpp v87, v84 quad_perm:[3,3,3,3] row_mask:0xf bank_mask:0xf
    s_mov_b64 exec, 0x1111
    global_store_dwordx4 v14, v[84:87], s[26:27] sc1
    global_store_dwordx4 v15, v[84:87], s[26:27] sc1
    ds_write_b128 v16, v[84:87] offset:64
    s_mov_b64 exec, 1
    ds_write_b32 v4, v3 offset:2704
    s_mov_b64 exec, -1
    s_cmp_lg_u32 s35, 0
    s_cbranch_scc1 L_D_end
    s_mov_b32 s35, 1
    s_add_u32 s33, s33, 1
    v_mov_b32 v6, s33
    v_and_b32 v7, 0xff, v6
    v_mov_b32 v4, 4
    v_add_u32 v14, 0x20000, v14
    v_add_u32 v15, 0x20000, v15
    v_add_u32 v16, 128, v16
    v_add_u32 v13, 1024, v13
    s_branch L_D3_loop
L_slow_11:
    global_store_dwordx4 v13, v[108:111], s[26:27] sc1
    s_branch L_ret_12
L_slow_13:
    global_store_dwordx4 v25, v[112:115], s[26:27] sc1
    s_branch L_ret_14
L_slow_20:
    global_store_dword v18, v160, s[26:27] sc1
    s_branch L_ret_21
L_slow_27:
    global_store_dword v19, v160, s[26:27] sc1
    s_branch L_ret_28
L_slow_50:
    global_store_dword v16, v128, s[26:27] sc1
    s_branch L_ret_51
L_slow_62:
    global_store_dwordx4 v21, v[124:127], s[26:27] sc1
    s_branch L_ret_63
L_slow_76:
    global_store_dwordx2 v14, v[124:125], s[26:27] sc1
    s_branch L_ret_77
L_slow_97:
    global_store_dword v14, v120, s[26:27] sc1
    s_branch L_ret_98
L_fail:
    s_mov_b64 exec, 1
    v_mov_b32 v2, s45
    v_mov_b32 v3, 0
    global_store_dword v3, v2, s[24:25]
    s_waitcnt vmcnt(0)
L_end:
    s_endpgm
.section .rodata,"a"
.p2align 6
.amdhsa_kernel interleave_layers__sliding_block_cached__glu_gated_swiglu__decode_kernel
  .amdhsa_next_free_vgpr 168
  .amdhsa_next_free_sgpr 102
  .amdhsa_accum_offset 168
  .amdhsa_group_segment_fixed_size 0
  .amdhsa_kernarg_size 96
  .amdhsa_user_sgpr_count 2
  .amdhsa_user_sgpr_kernarg_segment_ptr 1
  .amdhsa_system_sgpr_workgroup_id_x 1
.end_amdhsa_kernel
```
